```python
import torch

def _softmax(x, axis=-1):
    return torch.softmax(x, dim=axis)
def _gelu(x):
    return torch.nn.functional.gelu(x, approximate="tanh")
def _silu(x):
    return torch.nn.functional.silu(x)
def _sigmoid(x):
    return torch.sigmoid(x)
def _layernorm(x, axis=-1, eps=1e-5):
    m = x.mean(dim=axis, keepdim=True)
    v = x.var(dim=axis, keepdim=True, unbiased=False)
    return (x - m) / torch.sqrt(v + eps)
def _scatter_add(tgt, idx, src, axis=0):
    return tgt.clone().index_add_(axis, idx, src)
def _segment_sum(src, seg, n):
    out = torch.zeros((n,) + src.shape[1:], dtype=src.dtype)
    return out.index_add_(0, seg, src)
def _pad(x, pw):
    flat = tuple(v for pair in reversed(pw) for v in pair)
    return torch.nn.functional.pad(x, flat)

kernel_name = 'concat_heads__mha_block_cached__gqa_block_cached__decode'

def setup_inputs():

    _w = (lambda a: (lambda t: t.to(torch.bfloat16) if t.is_floating_point() else t)(torch.as_tensor(a)))
    def _A_setup():
        B, Sq, D = 1, 1, 640
        H, Sk, Dh = 32, 4096, 192
        return {
            "x": _w((lambda *s: torch.randn(*s, dtype=torch.bfloat16) * 0.8)(B, Sq, D)),
            "k_cache": _w((lambda *s: torch.randn(*s, dtype=torch.bfloat16) * 0.8)(B, H, Sk, Dh)),
            "v_cache": _w((lambda *s: torch.randn(*s, dtype=torch.bfloat16) * 0.05)(B, H, Sk, Dh)),
            "wq": _w((lambda *s: torch.randn(*s, dtype=torch.bfloat16) * 0.8)(D, H * Dh) * (D ** -0.5)),
            "wo": _w((lambda *s: torch.randn(*s, dtype=torch.bfloat16) * 0.05)(H * Dh, D) * ((H * Dh) ** -0.5)),
        }
    _A_in = _A_setup()

    def _B_setup():
        B, Sq, D = 1, 1, 640
        Hq, Hkv, Sk, Dh = 32, 32, 4096, 192
        assert Hq % Hkv == 0, (Hq, Hkv)
        return {
            "x": _w((lambda *s: torch.randn(*s, dtype=torch.bfloat16) * 0.8)(B, Sq, D)),
            "k_cache": _w((lambda *s: torch.randn(*s, dtype=torch.bfloat16) * 0.8)(B, Hkv, Sk, Dh)),
            "v_cache": _w((lambda *s: torch.randn(*s, dtype=torch.bfloat16) * 0.05)(B, Hkv, Sk, Dh)),
            "wq": _w((lambda *s: torch.randn(*s, dtype=torch.bfloat16) * 0.8)(D, Hq * Dh) * (D ** -0.5)),
            "wo": _w((lambda *s: torch.randn(*s, dtype=torch.bfloat16) * 0.05)(Hq * Dh, D) * ((Hq * Dh) ** -0.5)),
        }
    _B_in = _B_setup()

    return {
        "A_x": _A_in["x"],
        "A_k_cache": _A_in["k_cache"],
        "A_v_cache": _A_in["v_cache"],
        "A_wq": _A_in["wq"],
        "A_wo": _A_in["wo"],
        "B_x": _B_in["x"],
        "B_k_cache": _B_in["k_cache"],
        "B_v_cache": _B_in["v_cache"],
        "B_wq": _B_in["wq"],
        "B_wo": _B_in["wo"],
    }

def reference(A_x, A_k_cache, A_v_cache, A_wq, A_wo, B_x, B_k_cache, B_v_cache, B_wq, B_wo):
    def _A_ref(x, k_cache, v_cache, wq, wo):
        B, Sq, D = x.shape
        H, Dh = 32, 192
        q = (lambda x, *d: x.permute(*d))((x @ wq).reshape(B, Sq, H, Dh), 0, 2, 1, 3)
        scores = torch.einsum("bhqd,bhkd->bhqk", q, k_cache) * (Dh ** -0.5)
        p = _softmax(scores, axis=-1)
        o = torch.einsum("bhqk,bhkd->bhqd", p, v_cache)
        return (lambda x, *d: x.permute(*d))(o, 0, 2, 1, 3).reshape(B, Sq, H * Dh) @ wo

    def _B_ref(x, k_cache, v_cache, wq, wo):
        B, Sq, D = x.shape
        Hq, Dh = 32, 192
        Hkv = k_cache.shape[1]
        rep = Hq // Hkv
        q = (lambda x, *d: x.permute(*d))((x @ wq).reshape(B, Sq, Hq, Dh), 0, 2, 1, 3)
        k = (lambda x, n, axis: torch.repeat_interleave(x, n, dim=axis))(k_cache, rep, axis=1)
        v = (lambda x, n, axis: torch.repeat_interleave(x, n, dim=axis))(v_cache, rep, axis=1)
        scores = torch.einsum("bhqd,bhkd->bhqk", q, k) * (Dh ** -0.5)
        p = _softmax(scores, axis=-1)
        o = torch.einsum("bhqk,bhkd->bhqd", p, v)
        return (lambda x, *d: x.permute(*d))(o, 0, 2, 1, 3).reshape(B, Sq, Hq * Dh) @ wo

    a = _A_ref(A_x, A_k_cache, A_v_cache, A_wq, A_wo)
    b = _B_ref(B_x, B_k_cache, B_v_cache, B_wq, B_wo)
    return torch.concatenate([a, b], axis=-1)
```

```asm
; @launch grid=(256,1,1) block=(384,1,1) lds=8448
.amdgcn_target "amdgcn-amd-amdhsa--gfx950"
.text
.globl concat_heads__mha_block_cached__gqa_block_cached__decode_kernel
.p2align 8
.type concat_heads__mha_block_cached__gqa_block_cached__decode_kernel,@function
concat_heads__mha_block_cached__gqa_block_cached__decode_kernel:
    s_cmpk_ge_u32 s2, 256
    s_cbranch_scc1 L_end
    s_lshr_b32 s12, s2, 7
    s_mul_i32 s7, s12, 40
    s_load_dwordx8 s[40:47], s[0:1], s7
    v_lshrrev_b32 v49, 3, v0
    v_and_b32 v50, 7, v0
    v_mul_u32_u24 v2, 12288, v49
    v_lshl_add_u32 v2, v50, 4, v2
    s_lshr_b32 s3, s2, 5
    s_and_b32 s5, s2, 7
    s_lshl3_add_u32 s11, s3, s5
    s_and_b32 s13, s11, 31
    s_and_b32 s4, s2, 24
    s_mulk_i32 s4, 640
    s_add_u32 s4, s4, s13
    s_mulk_i32 s4, 384
    v_readfirstlane_b32 s14, v0
    v_add_u32 v2, s4, v2
    s_cmpk_ge_u32 s14, 256
    s_cbranch_scc1 L_other
    s_waitcnt lgkmcnt(0)
    global_load_dwordx4 v[88:91], v2, s[46:47] offset:0 nt
    global_load_dwordx4 v[92:95], v2, s[46:47] offset:128 nt
    s_bfe_u32 s10, s2, 0x20003
    s_mul_i32 s3, s10, 320
    v_lshl_add_u32 v52, v49, 1, s3
    global_load_ushort v44, v52, s[40:41] offset:0
    global_load_ushort v45, v52, s[40:41] offset:64
    global_load_ushort v46, v52, s[40:41] offset:128
    global_load_ushort v47, v52, s[40:41] offset:192
    global_load_ushort v48, v52, s[40:41] offset:256
    global_load_dwordx4 v[96:99], v2, s[46:47] offset:256 nt
    v_add_u32 v2, 393216, v2
    global_load_dwordx4 v[100:103], v2, s[46:47] offset:0 nt
    global_load_dwordx4 v[104:107], v2, s[46:47] offset:128 nt
    global_load_dwordx4 v[108:111], v2, s[46:47] offset:256 nt
    s_load_dwordx2 s[26:27], s[0:1], s7 offset:32
    s_load_dwordx2 s[28:29], s[0:1], 80
    s_load_dwordx2 s[30:31], s[0:1], 96
    s_lshr_b32 s14, s14, 6
    v_and_b32 v0, 63, v0
    s_lshl_b32 s15, s13, 2
    s_add_u32 s15, s15, s10
    s_min_u32 s97, s14, 4
    s_and_b32 s62, s10, 1
    s_mul_i32 s63, s62, 3
    s_bfe_u32 s64, s97, 0x10001
    s_add_u32 s63, s63, s64
    s_and_b32 s64, s97, 1
    s_cmp_eq_u32 s97, 0
    s_cselect_b32 s63, 2, s63
    s_cselect_b32 s98, s62, s64
    s_lshr_b32 s62, s10, 1
    s_mul_i32 s62, s62, 5
    s_add_u32 s63, s63, s62
    s_lshl_b32 s63, s63, 7
    s_mov_b32 s96, s63
    s_mul_i32 s6, s13, 245760
    s_add_u32 s6, s6, s63
    s_mul_i32 s62, s98, 122880
    s_add_u32 s6, s6, s62
    v_lshrrev_b32 v49, 3, v0
    v_lshlrev_b32 v51, 4, v50
    v_mul_u32_u24 v1, 384, v49
    v_add_u32 v1, v1, v51
    v_add_u32 v38, 6144, v51
    s_mul_i32 s5, s13, 1572864
    s_mul_i32 s7, s10, 393216
    s_add_u32 s5, s5, s7
    s_mul_i32 s7, s14, 3072
    s_add_u32 s5, s5, s7
    s_and_b32 s7, s11, 7
    s_mul_i32 s100, s7, 4
    s_mul_i32 s7, s10, 8
    s_add_u32 s100, s100, s7
    s_lshr_b32 s7, s11, 3
    s_mul_i32 s7, s7, 1
    s_add_u32 s100, s100, s7
    s_and_b32 s100, s100, 31
    s_mul_i32 s100, s100, 12288
    s_add_u32 s40, s42, s5
    s_addc_u32 s41, s43, 0
    s_sub_u32 s42, 50331648, s5
    s_mov_b32 s43, 0x20000
    s_add_u32 s44, s44, s5
    s_addc_u32 s45, s45, 0
    s_waitcnt lgkmcnt(0)
    v_and_b32 v49, 1, v0
    v_lshlrev_b32 v49, 4, v49
    v_mov_b32 v50, 0xffff
    v_lshlrev_b32 v49, v49, v50
    v_bfe_u32 v50, v0, 1, 2
    v_cmp_eq_u32 vcc, 0, v50
    s_nop 1
    v_cndmask_b32 v4, 0, v49, vcc
    v_cmp_eq_u32 vcc, 1, v50
    s_nop 1
    v_cndmask_b32 v5, 0, v49, vcc
    v_cmp_eq_u32 vcc, 2, v50
    s_nop 1
    v_cndmask_b32 v6, 0, v49, vcc
    v_cmp_eq_u32 vcc, 3, v50
    s_nop 1
    v_cndmask_b32 v7, 0, v49, vcc
    v_lshrrev_b32 v49, 3, v0
    v_and_b32 v50, 7, v0
    v_mul_u32_u24 v3, 15360, v49
    v_lshl_add_u32 v3, v50, 4, v3
    s_mul_i32 s7, s98, 384
    s_add_u32 s7, s7, 6592
    v_mul_u32_u24 v39, 48, v49
    v_add_u32 v39, s7, v39
    v_mul_u32_u24 v40, 256, v49
    v_lshl_add_u32 v40, v50, 3, v40
    s_lshr_b32 s7, s96, 7
    s_mul_i32 s8, s12, 10
    s_add_u32 s7, s7, s8
    s_mul_i32 s7, s7, 2048
    s_add_u32 s7, s7, 2691072
    v_add_u32 v40, s7, v40
    v_mov_b32 v53, 0
    v_mov_b32 v54, 1
    s_mov_b32 s62, 117835008
    s_mov_b32 s63, 117835009
    s_mov_b32 s64, 117835010
    s_mov_b32 s65, 117835011
    s_add_u32 s48, s26, s6
    s_addc_u32 s49, s27, 0
    s_sub_u32 s50, 7864320, s6
    s_mov_b32 s51, 0x20000
    s_mov_b32 s52, s30
    s_mov_b32 s53, s31
    s_mov_b32 s54, 2732032
    s_mov_b32 s55, 0x20000
    s_mov_b32 s56, s28
    s_mov_b32 s57, s29
    s_mov_b32 s58, 2560
    s_mov_b32 s59, 0x20000
    v_lshrrev_b32 v49, 5, v0
    v_mul_u32_u24 v37, 768, v49
    v_and_b32 v49, 7, v0
    v_lshl_add_u32 v37, v49, 5, v37
    v_bfe_u32 v49, v0, 4, 1
    v_lshl_add_u32 v37, v49, 4, v37
    s_mul_i32 s7, s14, 1536
    v_add_u32 v37, s7, v37
    s_mov_b32 s61, 0x3dd53b95
    v_mov_b32 v56, 0
    v_mov_b32 v57, 0
    v_mov_b32 v58, 0
    v_mov_b32 v59, 0
    v_mov_b32 v60, 0
    v_mov_b32 v61, 0
    v_mov_b32 v62, 0
    v_mov_b32 v63, 0
    v_mov_b32 v64, 0
    v_mov_b32 v65, 0
    v_mov_b32 v66, 0
    v_mov_b32 v67, 0
    v_mov_b32 v68, 0
    v_mov_b32 v69, 0
    v_mov_b32 v70, 0
    v_mov_b32 v71, 0
    v_mov_b32 v72, 0
    v_mov_b32 v73, 0
    v_mov_b32 v74, 0
    v_mov_b32 v75, 0
    v_mov_b32 v76, 0
    v_mov_b32 v77, 0
    v_mov_b32 v78, 0
    v_mov_b32 v79, 0
    v_mov_b32 v80, 0
    v_mov_b32 v81, 0
    v_mov_b32 v82, 0
    v_mov_b32 v83, 0
    v_mov_b32 v84, 0
    v_mov_b32 v85, 0
    v_mov_b32 v86, 0
    v_mov_b32 v87, 0
    s_waitcnt vmcnt(4)
    s_mov_b64 vcc, 0
    v_lshl_or_b32 v49, v44, 16, v44
    v_and_b32 v32, v49, v4
    v_and_b32 v33, v49, v5
    v_and_b32 v34, v49, v6
    v_and_b32 v35, v49, v7
    s_nop 1
    v_mfma_f32_16x16x32_bf16 v[20:23], v[32:35], v[88:91], 0
    v_add_u32 v2, 393216, v2
    global_load_dwordx4 v[112:115], v2, s[46:47] offset:0 nt
    v_mfma_f32_16x16x32_bf16 v[24:27], v[32:35], v[92:95], 0
    s_waitcnt vmcnt(4)
    global_load_dwordx4 v[116:119], v2, s[46:47] offset:128 nt
    v_mfma_f32_16x16x32_bf16 v[28:31], v[32:35], v[96:99], 0
    s_waitcnt vmcnt(4)
    global_load_dwordx4 v[120:123], v2, s[46:47] offset:256 nt
    v_lshl_or_b32 v49, v45, 16, v45
    v_and_b32 v32, v49, v4
    v_and_b32 v33, v49, v5
    v_and_b32 v34, v49, v6
    v_and_b32 v35, v49, v7
    s_nop 1
    v_mfma_f32_16x16x32_bf16 v[20:23], v[32:35], v[100:103], v[20:23]
    s_waitcnt vmcnt(4)
    v_add_u32 v2, 393216, v2
    global_load_dwordx4 v[124:127], v2, s[46:47] offset:0 nt
    v_mfma_f32_16x16x32_bf16 v[24:27], v[32:35], v[104:107], v[24:27]
    s_waitcnt vmcnt(4)
    global_load_dwordx4 v[128:131], v2, s[46:47] offset:128 nt
    v_mfma_f32_16x16x32_bf16 v[28:31], v[32:35], v[108:111], v[28:31]
    s_waitcnt vmcnt(4)
    global_load_dwordx4 v[132:135], v2, s[46:47] offset:256 nt
    v_lshl_or_b32 v49, v46, 16, v46
    v_and_b32 v32, v49, v4
    v_and_b32 v33, v49, v5
    v_and_b32 v34, v49, v6
    v_and_b32 v35, v49, v7
    s_nop 1
    v_mfma_f32_16x16x32_bf16 v[20:23], v[32:35], v[112:115], v[20:23]
    s_waitcnt vmcnt(4)
    v_add_u32 v2, 393216, v2
    global_load_dwordx4 v[136:139], v2, s[46:47] offset:0 nt
    v_mfma_f32_16x16x32_bf16 v[24:27], v[32:35], v[116:119], v[24:27]
    s_waitcnt vmcnt(4)
    global_load_dwordx4 v[140:143], v2, s[46:47] offset:128 nt
    v_mfma_f32_16x16x32_bf16 v[28:31], v[32:35], v[120:123], v[28:31]
    s_waitcnt vmcnt(4)
    global_load_dwordx4 v[144:147], v2, s[46:47] offset:256 nt
    s_mov_b32 s46, s42
    s_mov_b32 s47, 0x20000
    s_barrier
    v_lshl_or_b32 v49, v47, 16, v47
    v_and_b32 v32, v49, v4
    v_and_b32 v33, v49, v5
    v_and_b32 v34, v49, v6
    v_and_b32 v35, v49, v7
    s_nop 1
    v_mfma_f32_16x16x32_bf16 v[20:23], v[32:35], v[124:127], v[20:23]
    s_waitcnt vmcnt(4)
    s_mov_b64 exec, 1
    ds_add_rtn_u32 v55, v53, v54 offset:6556
    s_mov_b64 exec, -1
    s_mov_b32 s60, s100
    buffer_load_dwordx4 v[148:151], v1, s[40:43], s60 offen offset:0 nt
    v_mfma_f32_16x16x32_bf16 v[24:27], v[32:35], v[128:131], v[24:27]
    s_waitcnt vmcnt(4)
    buffer_load_dwordx4 v[152:155], v1, s[40:43], s60 offen offset:128 nt
    v_mfma_f32_16x16x32_bf16 v[28:31], v[32:35], v[132:135], v[28:31]
    s_waitcnt vmcnt(4)
    buffer_load_dwordx4 v[156:159], v1, s[40:43], s60 offen offset:256 nt
    v_lshl_or_b32 v49, v48, 16, v48
    v_and_b32 v32, v49, v4
    v_and_b32 v33, v49, v5
    v_and_b32 v34, v49, v6
    v_and_b32 v35, v49, v7
    s_nop 1
    v_mfma_f32_16x16x32_bf16 v[20:23], v[32:35], v[136:139], v[20:23]
    s_cbranch_vccnz L_c1
    s_waitcnt vmcnt(4)
L_c1:
    s_mov_b64 exec, 1
    s_waitcnt lgkmcnt(0)
    v_cmp_lt_i32 vcc, 1, v55
    v_readfirstlane_b32 s8, v55
    ds_add_rtn_u32 v55, v53, v54 offset:6556
    s_mov_b64 exec, -1
    s_add_u32 s60, s60, 12288
    s_cmp_eq_u32 s60, 393216
    s_cselect_b32 s60, 0, s60
    s_cmp_gt_i32 s8, 3
    buffer_load_dwordx4 v[160:163], v1, s[40:43], s60 offen offset:0 nt
    s_waitcnt vmcnt(5)
    v_mfma_f32_16x16x32_bf16 v[24:27], v[32:35], v[140:143], v[24:27]
    s_cbranch_vccnz L_c2
    s_waitcnt vmcnt(4)
L_c2:
    buffer_load_dwordx4 v[164:167], v1, s[40:43], s60 offen offset:128 nt
    s_waitcnt vmcnt(5)
    v_mfma_f32_16x16x32_bf16 v[28:31], v[32:35], v[144:147], v[28:31]
    s_mov_b32 exec_lo, 0x00ff00ff
    s_mov_b32 exec_hi, 0xff00ff00
    ds_write_b128 v37, v[20:23] offset:0
    s_nop 0
    ds_write_b128 v37, v[24:27] offset:256
    s_nop 2
    ds_write_b128 v37, v[28:31] offset:512
    s_mov_b64 exec, 1
    ds_add_u32 v53, v54 offset:6544
    s_mov_b64 exec, -1
    s_cbranch_vccnz L_c3
    s_waitcnt vmcnt(4)
L_c3:
    buffer_load_dwordx4 v[168:171], v1, s[40:43], s60 offen offset:256 nt
    s_cbranch_vccnz L_c4
    s_waitcnt vmcnt(4)
L_c4:
    s_mov_b64 exec, 1
    s_waitcnt lgkmcnt(0)
    v_cmp_lt_i32 vcc, 5, v55
    v_readfirstlane_b32 s8, v55
    ds_add_rtn_u32 v55, v53, v54 offset:6556
    s_mov_b64 exec, -1
    s_add_u32 s60, s60, 12288
    s_cmp_eq_u32 s60, 393216
    s_cselect_b32 s60, 0, s60
    s_cmp_gt_i32 s8, 7
    buffer_load_dwordx4 v[172:175], v1, s[40:43], s60 offen offset:0 nt
    s_cbranch_vccnz L_c5
    s_waitcnt vmcnt(4)
L_c5:
    buffer_load_dwordx4 v[176:179], v1, s[40:43], s60 offen offset:128 nt
    s_cbranch_scc1 L_c6
    s_waitcnt vmcnt(7)
    s_cbranch_vccnz L_c6
    s_waitcnt vmcnt(4)
L_c6:
    buffer_load_dwordx4 v[180:183], v1, s[40:43], s60 offen offset:256 nt
    s_cbranch_scc1 L_c7
    s_waitcnt vmcnt(7)
    s_cbranch_vccnz L_c7
    s_waitcnt vmcnt(4)
L_c7:
    s_mov_b64 exec, 1
    s_waitcnt lgkmcnt(0)
    v_cmp_lt_i32 vcc, 9, v55
    v_readfirstlane_b32 s8, v55
    ds_add_rtn_u32 v55, v53, v54 offset:6556
    s_mov_b64 exec, -1
    s_add_u32 s60, s60, 12288
    s_cmp_eq_u32 s60, 393216
    s_cselect_b32 s60, 0, s60
    s_cmp_gt_i32 s8, 11
    buffer_load_dwordx4 v[184:187], v1, s[40:43], s60 offen offset:0 nt
    s_cbranch_scc1 L_c8
    s_waitcnt vmcnt(7)
    s_cbranch_vccnz L_c8
    s_waitcnt vmcnt(4)
L_c8:
    buffer_load_dwordx4 v[188:191], v1, s[40:43], s60 offen offset:128 nt
    s_cbranch_scc1 L_c9
    s_waitcnt vmcnt(7)
    s_cbranch_vccnz L_c9
    s_waitcnt vmcnt(4)
L_c9:
    buffer_load_dwordx4 v[192:195], v1, s[40:43], s60 offen offset:256 nt
    s_waitcnt vmcnt(11)
    s_cbranch_scc1 L_c10
    s_waitcnt vmcnt(7)
    s_cbranch_vccnz L_c10
    s_waitcnt vmcnt(4)
L_c10:
    s_mov_b64 exec, 1
    s_waitcnt lgkmcnt(0)
    v_cmp_lt_i32 vcc, 13, v55
    v_readfirstlane_b32 s8, v55
    ds_add_rtn_u32 v55, v53, v54 offset:6556
    s_mov_b64 exec, -1
    s_add_u32 s60, s60, 12288
    s_cmp_eq_u32 s60, 393216
    s_cselect_b32 s60, 0, s60
    s_cmp_gt_i32 s8, 15
    buffer_load_dwordx4 v[196:199], v1, s[40:43], s60 offen offset:0 nt
    s_waitcnt vmcnt(11)
    s_cbranch_scc1 L_c11
    s_waitcnt vmcnt(7)
    s_cbranch_vccnz L_c11
    s_waitcnt vmcnt(4)
L_c11:
    buffer_load_dwordx4 v[200:203], v1, s[40:43], s60 offen offset:128 nt
    s_waitcnt vmcnt(11)
    s_cbranch_scc1 L_c12
    s_waitcnt vmcnt(7)
    s_cbranch_vccnz L_c12
    s_waitcnt vmcnt(4)
L_c12:
    buffer_load_dwordx4 v[204:207], v1, s[40:43], s60 offen offset:256 nt
    s_waitcnt vmcnt(11)
    s_cbranch_scc1 L_c13
    s_waitcnt vmcnt(7)
    s_cbranch_vccnz L_c13
    s_waitcnt vmcnt(4)
L_c13:
    s_mov_b64 exec, 1
    s_waitcnt lgkmcnt(0)
    v_cmp_lt_i32 vcc, 17, v55
    v_readfirstlane_b32 s8, v55
    ds_add_rtn_u32 v55, v53, v54 offset:6556
    s_mov_b64 exec, -1
    s_add_u32 s60, s60, 12288
    s_cmp_eq_u32 s60, 393216
    s_cselect_b32 s60, 0, s60
    s_cmp_gt_i32 s8, 19
    buffer_load_dwordx4 v[208:211], v1, s[40:43], s60 offen offset:0 nt
    s_waitcnt vmcnt(11)
    s_cbranch_scc1 L_c14
    s_waitcnt vmcnt(7)
    s_cbranch_vccnz L_c14
    s_waitcnt vmcnt(4)
L_c14:
    buffer_load_dwordx4 v[212:215], v1, s[40:43], s60 offen offset:128 nt
    s_waitcnt vmcnt(11)
    s_cbranch_scc1 L_c15
    s_waitcnt vmcnt(7)
    s_cbranch_vccnz L_c15
    s_waitcnt vmcnt(4)
L_c15:
    buffer_load_dwordx4 v[216:219], v1, s[40:43], s60 offen offset:256 nt
    s_waitcnt vmcnt(11)
    s_cbranch_scc1 L_c16
    s_waitcnt vmcnt(7)
    s_cbranch_vccnz L_c16
    s_waitcnt vmcnt(4)
L_c16:
    s_mov_b64 exec, 1
    s_waitcnt lgkmcnt(0)
    v_cmp_lt_i32 vcc, 21, v55
    v_readfirstlane_b32 s8, v55
    ds_add_rtn_u32 v55, v53, v54 offset:6556
    s_mov_b64 exec, -1
    s_add_u32 s60, s60, 12288
    s_cmp_eq_u32 s60, 393216
    s_cselect_b32 s60, 0, s60
    s_cmp_gt_i32 s8, 23
    buffer_load_dwordx4 v[220:223], v1, s[40:43], s60 offen offset:0 nt
    s_waitcnt vmcnt(11)
    s_cbranch_scc1 L_c17
    s_waitcnt vmcnt(7)
    s_cbranch_vccnz L_c17
    s_waitcnt vmcnt(4)
L_c17:
    buffer_load_dwordx4 v[224:227], v1, s[40:43], s60 offen offset:128 nt
    s_waitcnt vmcnt(11)
    s_cbranch_scc1 L_c18
    s_waitcnt vmcnt(7)
    s_cbranch_vccnz L_c18
    s_waitcnt vmcnt(4)
L_c18:
    buffer_load_dwordx4 v[228:231], v1, s[40:43], s60 offen offset:256 nt
    s_waitcnt vmcnt(11)
    s_cbranch_scc1 L_c19
    s_waitcnt vmcnt(7)
    s_cbranch_vccnz L_c19
    s_waitcnt vmcnt(4)
L_c19:
    s_mov_b64 exec, 1
    s_waitcnt lgkmcnt(0)
    v_cmp_lt_i32 vcc, 25, v55
    v_readfirstlane_b32 s8, v55
    ds_add_rtn_u32 v55, v53, v54 offset:6556
    s_mov_b64 exec, -1
    s_add_u32 s60, s60, 12288
    s_cmp_eq_u32 s60, 393216
    s_cselect_b32 s60, 0, s60
    s_cmp_gt_i32 s8, 27
    buffer_load_dwordx4 v[232:235], v1, s[40:43], s60 offen offset:0 nt
    s_waitcnt vmcnt(11)
    s_cbranch_scc1 L_c20
    s_waitcnt vmcnt(7)
    s_cbranch_vccnz L_c20
    s_waitcnt vmcnt(4)
L_c20:
    buffer_load_dwordx4 v[236:239], v1, s[40:43], s60 offen offset:128 nt
    s_waitcnt vmcnt(11)
    s_cbranch_scc1 L_c21
    s_waitcnt vmcnt(7)
    s_cbranch_vccnz L_c21
    s_waitcnt vmcnt(4)
L_c21:
    buffer_load_dwordx4 v[240:243], v1, s[40:43], s60 offen offset:256 nt
    s_waitcnt vmcnt(11)
    s_cbranch_scc1 L_c22
    s_waitcnt vmcnt(7)
    s_cbranch_vccnz L_c22
    s_waitcnt vmcnt(4)
L_c22:
    s_mov_b64 exec, 1
    s_waitcnt lgkmcnt(0)
    v_cmp_lt_i32 vcc, 29, v55
    v_readfirstlane_b32 s8, v55
    ds_add_rtn_u32 v55, v53, v54 offset:6556
    s_mov_b64 exec, -1
    s_add_u32 s60, s60, 12288
    s_cmp_eq_u32 s60, 393216
    s_cselect_b32 s60, 0, s60
    s_cmp_gt_i32 s8, 31
    buffer_load_dwordx4 v[244:247], v1, s[40:43], s60 offen offset:0 nt
    s_waitcnt vmcnt(11)
    s_cbranch_scc1 L_c23
    s_waitcnt vmcnt(7)
    s_cbranch_vccnz L_c23
    s_waitcnt vmcnt(4)
L_c23:
    buffer_load_dwordx4 v[248:251], v1, s[40:43], s60 offen offset:128 nt
    s_waitcnt vmcnt(11)
    s_cbranch_scc1 L_c24
    s_waitcnt vmcnt(7)
    s_cbranch_vccnz L_c24
    s_waitcnt vmcnt(4)
L_c24:
    buffer_load_dwordx4 v[252:255], v1, s[40:43], s60 offen offset:256 nt
    s_waitcnt vmcnt(11)
    s_cbranch_scc1 L_c25
    s_waitcnt vmcnt(7)
    s_cbranch_vccnz L_c25
    s_waitcnt vmcnt(4)
L_c25:
    s_mov_b64 exec, 1
    s_waitcnt lgkmcnt(0)
    v_cmp_lt_i32 vcc, 33, v55
    v_readfirstlane_b32 s8, v55
    ds_add_rtn_u32 v55, v53, v54 offset:6556
    s_mov_b64 exec, -1
    s_add_u32 s60, s60, 12288
    s_cmp_eq_u32 s60, 393216
    s_cselect_b32 s60, 0, s60
    s_cmp_gt_i32 s8, 35
    buffer_load_dwordx4 v[88:91], v1, s[40:43], s60 offen offset:0 nt
    s_waitcnt vmcnt(11)
    s_cbranch_scc1 L_c26
    s_waitcnt vmcnt(7)
    s_cbranch_vccnz L_c26
    s_waitcnt vmcnt(4)
L_c26:
    buffer_load_dwordx4 v[92:95], v1, s[40:43], s60 offen offset:128 nt
    s_waitcnt vmcnt(11)
    s_cbranch_scc1 L_c27
    s_waitcnt vmcnt(7)
    s_cbranch_vccnz L_c27
    s_waitcnt vmcnt(4)
L_c27:
    buffer_load_dwordx4 v[96:99], v1, s[40:43], s60 offen offset:256 nt
    s_waitcnt vmcnt(11)
    s_cbranch_scc1 L_c28
    s_waitcnt vmcnt(7)
    s_cbranch_vccnz L_c28
    s_waitcnt vmcnt(4)
L_c28:
    s_mov_b64 exec, 1
    s_waitcnt lgkmcnt(0)
    v_cmp_lt_i32 vcc, 37, v55
    v_readfirstlane_b32 s8, v55
    ds_add_rtn_u32 v55, v53, v54 offset:6556
    s_mov_b64 exec, -1
    s_add_u32 s60, s60, 12288
    s_cmp_eq_u32 s60, 393216
    s_cselect_b32 s60, 0, s60
    s_cmp_gt_i32 s8, 39
    buffer_load_dwordx4 v[100:103], v1, s[40:43], s60 offen offset:0 nt
    s_waitcnt vmcnt(11)
    s_cbranch_scc1 L_c29
    s_waitcnt vmcnt(7)
    s_cbranch_vccnz L_c29
    s_waitcnt vmcnt(4)
L_c29:
    buffer_load_dwordx4 v[104:107], v1, s[40:43], s60 offen offset:128 nt
    s_waitcnt vmcnt(11)
    s_cbranch_scc1 L_c30
    s_waitcnt vmcnt(7)
    s_cbranch_vccnz L_c30
    s_waitcnt vmcnt(4)
L_c30:
    buffer_load_dwordx4 v[108:111], v1, s[40:43], s60 offen offset:256 nt
    s_waitcnt vmcnt(11)
    s_cbranch_scc1 L_c31
    s_waitcnt vmcnt(7)
    s_cbranch_vccnz L_c31
    s_waitcnt vmcnt(4)
L_c31:
    s_mov_b64 exec, 1
    s_waitcnt lgkmcnt(0)
    v_cmp_lt_i32 vcc, 41, v55
    v_readfirstlane_b32 s8, v55
    ds_add_rtn_u32 v55, v53, v54 offset:6556
    s_mov_b64 exec, -1
    s_add_u32 s60, s60, 12288
    s_cmp_eq_u32 s60, 393216
    s_cselect_b32 s60, 0, s60
    s_cmp_gt_i32 s8, 43
    buffer_load_dwordx4 v[112:115], v1, s[40:43], s60 offen offset:0 nt
    s_waitcnt vmcnt(11)
    s_cbranch_scc1 L_c32
    s_waitcnt vmcnt(7)
    s_cbranch_vccnz L_c32
    s_waitcnt vmcnt(4)
L_c32:
    buffer_load_dwordx4 v[116:119], v1, s[40:43], s60 offen offset:128 nt
    s_waitcnt vmcnt(11)
    s_cbranch_scc1 L_c33
    s_waitcnt vmcnt(7)
    s_cbranch_vccnz L_c33
    s_waitcnt vmcnt(4)
L_c33:
    buffer_load_dwordx4 v[120:123], v1, s[40:43], s60 offen offset:256 nt
    s_waitcnt vmcnt(11)
    s_cbranch_scc1 L_c34
    s_waitcnt vmcnt(7)
    s_cbranch_vccnz L_c34
    s_waitcnt vmcnt(4)
L_c34:
    s_mov_b64 exec, 1
    s_waitcnt lgkmcnt(0)
    v_cmp_lt_i32 vcc, 45, v55
    v_readfirstlane_b32 s8, v55
    ds_add_rtn_u32 v55, v53, v54 offset:6556
    s_mov_b64 exec, -1
    s_add_u32 s60, s60, 12288
    s_cmp_eq_u32 s60, 393216
    s_cselect_b32 s60, 0, s60
    s_cmp_gt_i32 s8, 47
    buffer_load_dwordx4 v[124:127], v1, s[40:43], s60 offen offset:0 nt
    s_waitcnt vmcnt(11)
    s_cbranch_scc1 L_c35
    s_waitcnt vmcnt(7)
    s_cbranch_vccnz L_c35
    s_waitcnt vmcnt(4)
L_c35:
    buffer_load_dwordx4 v[128:131], v1, s[40:43], s60 offen offset:128 nt
    s_waitcnt vmcnt(11)
    s_cbranch_scc1 L_c36
    s_waitcnt vmcnt(7)
    s_cbranch_vccnz L_c36
    s_waitcnt vmcnt(4)
L_c36:
    buffer_load_dwordx4 v[132:135], v1, s[40:43], s60 offen offset:256 nt
    s_waitcnt vmcnt(11)
    s_cbranch_scc1 L_c37
    s_waitcnt vmcnt(7)
    s_cbranch_vccnz L_c37
    s_waitcnt vmcnt(4)
L_c37:
    s_mov_b64 exec, 1
    s_waitcnt lgkmcnt(0)
    v_cmp_lt_i32 vcc, 49, v55
    v_readfirstlane_b32 s8, v55
    ds_add_rtn_u32 v55, v53, v54 offset:6556
    s_mov_b64 exec, -1
    s_add_u32 s60, s60, 12288
    s_cmp_eq_u32 s60, 393216
    s_cselect_b32 s60, 0, s60
    s_cmp_gt_i32 s8, 51
    buffer_load_dwordx4 v[136:139], v1, s[40:43], s60 offen offset:0 nt
    s_waitcnt vmcnt(11)
    s_cbranch_scc1 L_c38
    s_waitcnt vmcnt(7)
    s_cbranch_vccnz L_c38
    s_waitcnt vmcnt(4)
L_c38:
    buffer_load_dwordx4 v[140:143], v1, s[40:43], s60 offen offset:128 nt
    ds_read_b32 v50, v53 offset:6532
    ds_read_b128 v[8:11], v38 offset:0
    ds_read_b128 v[12:15], v38 offset:128
    ds_read_b128 v[16:19], v38 offset:256
    ds_read_b32 v36, v53 offset:6528
    s_waitcnt vmcnt(11)
    s_cbranch_scc1 L_c39
    s_waitcnt vmcnt(7)
    s_cbranch_vccnz L_c39
    s_waitcnt vmcnt(4)
L_c39:
    buffer_load_dwordx4 v[144:147], v1, s[40:43], s60 offen offset:256 nt
    s_mov_b32 s19, 4000000
L_q:
    s_waitcnt lgkmcnt(0)
    v_readfirstlane_b32 s3, v50
    s_sub_u32 s19, s19, 1
    s_cbranch_scc1 L_qx
    s_cmp_lg_u32 s3, 0
    s_cbranch_scc1 L_qx
    ds_read_b32 v50, v53 offset:6532
    ds_read_b128 v[8:11], v38 offset:0
    ds_read_b128 v[12:15], v38 offset:128
    ds_read_b128 v[16:19], v38 offset:256
    ds_read_b32 v36, v53 offset:6528
    s_branch L_q
L_qx:
    v_dot2c_f32_bf16 v56, v148, v8
    v_dot2c_f32_bf16 v56, v149, v9
    v_dot2c_f32_bf16 v56, v150, v10
    v_dot2c_f32_bf16 v56, v151, v11
    s_waitcnt vmcnt(11)
    s_cbranch_scc1 L_c40
    s_waitcnt vmcnt(7)
    s_cbranch_vccnz L_c40
    s_waitcnt vmcnt(4)
L_c40:
    s_mov_b64 exec, 1
    s_waitcnt lgkmcnt(0)
    v_cmp_lt_i32 vcc, 53, v55
    v_readfirstlane_b32 s8, v55
    ds_add_rtn_u32 v55, v53, v54 offset:6556
    s_mov_b64 exec, -1
    s_add_u32 s60, s60, 12288
    s_cmp_eq_u32 s60, 393216
    s_cselect_b32 s60, 0, s60
    s_cmp_gt_i32 s8, 55
    buffer_load_dwordx4 v[148:151], v1, s[40:43], s60 offen offset:0 nt
    v_dot2c_f32_bf16 v56, v152, v12
    v_dot2c_f32_bf16 v56, v153, v13
    v_dot2c_f32_bf16 v56, v154, v14
    v_dot2c_f32_bf16 v56, v155, v15
    v_dot2c_f32_bf16 v56, v156, v16
    v_dot2c_f32_bf16 v56, v157, v17
    v_dot2c_f32_bf16 v56, v158, v18
    v_dot2c_f32_bf16 v56, v159, v19
    s_waitcnt vmcnt(11)
    s_cbranch_scc1 L_c41
    s_waitcnt vmcnt(7)
    s_cbranch_vccnz L_c41
    s_waitcnt vmcnt(4)
L_c41:
    buffer_load_dwordx4 v[152:155], v1, s[40:43], s60 offen offset:128 nt
    v_dot2c_f32_bf16 v57, v160, v8
    v_dot2c_f32_bf16 v57, v161, v9
    v_add_f32_dpp v56, v56, v56 quad_perm:[1,0,3,2] row_mask:0xf bank_mask:0xf
    v_dot2c_f32_bf16 v57, v162, v10
    v_dot2c_f32_bf16 v57, v163, v11
    v_add_f32_dpp v56, v56, v56 quad_perm:[2,3,0,1] row_mask:0xf bank_mask:0xf
    v_dot2c_f32_bf16 v57, v164, v12
    v_dot2c_f32_bf16 v57, v165, v13
    v_add_f32_dpp v56, v56, v56 row_half_mirror row_mask:0xf bank_mask:0xf
    v_dot2c_f32_bf16 v57, v166, v14
    v_dot2c_f32_bf16 v57, v167, v15
    v_mov_b32 v41, v56
    s_waitcnt vmcnt(11)
    s_cbranch_scc1 L_c42
    s_waitcnt vmcnt(7)
    s_cbranch_vccnz L_c42
    s_waitcnt vmcnt(4)
L_c42:
    buffer_load_dwordx4 v[156:159], v1, s[40:43], s60 offen offset:256 nt
    v_dot2c_f32_bf16 v57, v168, v16
    v_dot2c_f32_bf16 v57, v169, v17
    v_dot2c_f32_bf16 v57, v170, v18
    v_dot2c_f32_bf16 v57, v171, v19
    v_dot2c_f32_bf16 v58, v172, v8
    v_dot2c_f32_bf16 v58, v173, v9
    s_nop 0
    v_add_f32_dpp v57, v57, v57 quad_perm:[1,0,3,2] row_mask:0xf bank_mask:0xf
    v_dot2c_f32_bf16 v58, v174, v10
    v_dot2c_f32_bf16 v58, v175, v11
    v_add_f32_dpp v57, v57, v57 quad_perm:[2,3,0,1] row_mask:0xf bank_mask:0xf
    s_waitcnt vmcnt(11)
    s_cbranch_scc1 L_c43
    s_waitcnt vmcnt(7)
    s_cbranch_vccnz L_c43
    s_waitcnt vmcnt(4)
L_c43:
    s_mov_b64 exec, 1
    s_waitcnt lgkmcnt(0)
    v_cmp_lt_i32 vcc, 57, v55
    v_readfirstlane_b32 s8, v55
    ds_add_rtn_u32 v55, v53, v54 offset:6556
    s_mov_b64 exec, -1
    s_add_u32 s60, s60, 12288
    s_cmp_eq_u32 s60, 393216
    s_cselect_b32 s60, 0, s60
    s_cmp_gt_i32 s8, 59
    buffer_load_dwordx4 v[160:163], v1, s[40:43], s60 offen offset:0 nt
    v_dot2c_f32_bf16 v58, v176, v12
    v_dot2c_f32_bf16 v58, v177, v13
    v_add_f32_dpp v57, v57, v57 row_half_mirror row_mask:0xf bank_mask:0xf
    v_dot2c_f32_bf16 v58, v178, v14
    v_dot2c_f32_bf16 v58, v179, v15
    v_max_f32 v41, v41, v57
    v_dot2c_f32_bf16 v58, v180, v16
    v_dot2c_f32_bf16 v58, v181, v17
    v_dot2c_f32_bf16 v58, v182, v18
    v_dot2c_f32_bf16 v58, v183, v19
    s_waitcnt vmcnt(11)
    s_cbranch_scc1 L_c44
    s_waitcnt vmcnt(7)
    s_cbranch_vccnz L_c44
    s_waitcnt vmcnt(4)
L_c44:
    buffer_load_dwordx4 v[164:167], v1, s[40:43], s60 offen offset:128 nt
    v_dot2c_f32_bf16 v59, v184, v8
    v_dot2c_f32_bf16 v59, v185, v9
    v_add_f32_dpp v58, v58, v58 quad_perm:[1,0,3,2] row_mask:0xf bank_mask:0xf
    v_dot2c_f32_bf16 v59, v186, v10
    v_dot2c_f32_bf16 v59, v187, v11
    v_add_f32_dpp v58, v58, v58 quad_perm:[2,3,0,1] row_mask:0xf bank_mask:0xf
    v_dot2c_f32_bf16 v59, v188, v12
    v_dot2c_f32_bf16 v59, v189, v13
    v_add_f32_dpp v58, v58, v58 row_half_mirror row_mask:0xf bank_mask:0xf
    v_dot2c_f32_bf16 v59, v190, v14
    v_dot2c_f32_bf16 v59, v191, v15
    v_max_f32 v41, v41, v58
    s_waitcnt vmcnt(11)
    s_cbranch_scc1 L_c45
    s_waitcnt vmcnt(7)
    s_cbranch_vccnz L_c45
    s_waitcnt vmcnt(4)
L_c45:
    buffer_load_dwordx4 v[168:171], v1, s[40:43], s60 offen offset:256 nt
    v_dot2c_f32_bf16 v59, v192, v16
    v_dot2c_f32_bf16 v59, v193, v17
    v_dot2c_f32_bf16 v59, v194, v18
    v_dot2c_f32_bf16 v59, v195, v19
    v_dot2c_f32_bf16 v60, v196, v8
    v_dot2c_f32_bf16 v60, v197, v9
    s_nop 0
    v_add_f32_dpp v59, v59, v59 quad_perm:[1,0,3,2] row_mask:0xf bank_mask:0xf
    v_dot2c_f32_bf16 v60, v198, v10
    v_dot2c_f32_bf16 v60, v199, v11
    v_add_f32_dpp v59, v59, v59 quad_perm:[2,3,0,1] row_mask:0xf bank_mask:0xf
    s_waitcnt vmcnt(11)
    s_cbranch_scc1 L_c46
    s_waitcnt vmcnt(7)
    s_cbranch_vccnz L_c46
    s_waitcnt vmcnt(4)
L_c46:
    s_mov_b64 exec, 1
    s_waitcnt lgkmcnt(0)
    v_cmp_lt_i32 vcc, 61, v55
    v_readfirstlane_b32 s8, v55
    ds_add_rtn_u32 v55, v53, v54 offset:6556
    s_mov_b64 exec, -1
    s_add_u32 s60, s60, 12288
    s_cmp_eq_u32 s60, 393216
    s_cselect_b32 s60, 0, s60
    s_cmp_gt_i32 s8, 63
    buffer_load_dwordx4 v[172:175], v1, s[40:43], s60 offen offset:0 nt
    v_dot2c_f32_bf16 v60, v200, v12
    v_dot2c_f32_bf16 v60, v201, v13
    v_add_f32_dpp v59, v59, v59 row_half_mirror row_mask:0xf bank_mask:0xf
    v_dot2c_f32_bf16 v60, v202, v14
    v_dot2c_f32_bf16 v60, v203, v15
    v_max_f32 v41, v41, v59
    v_dot2c_f32_bf16 v60, v204, v16
    v_dot2c_f32_bf16 v60, v205, v17
    v_dot2c_f32_bf16 v60, v206, v18
    v_dot2c_f32_bf16 v60, v207, v19
    s_waitcnt vmcnt(11)
    s_cbranch_scc1 L_c47
    s_waitcnt vmcnt(7)
    s_cbranch_vccnz L_c47
    s_waitcnt vmcnt(4)
L_c47:
    buffer_load_dwordx4 v[176:179], v1, s[40:43], s60 offen offset:128 nt
    v_dot2c_f32_bf16 v61, v208, v8
    v_dot2c_f32_bf16 v61, v209, v9
    v_add_f32_dpp v60, v60, v60 quad_perm:[1,0,3,2] row_mask:0xf bank_mask:0xf
    v_dot2c_f32_bf16 v61, v210, v10
    v_dot2c_f32_bf16 v61, v211, v11
    v_add_f32_dpp v60, v60, v60 quad_perm:[2,3,0,1] row_mask:0xf bank_mask:0xf
    v_dot2c_f32_bf16 v61, v212, v12
    v_dot2c_f32_bf16 v61, v213, v13
    v_add_f32_dpp v60, v60, v60 row_half_mirror row_mask:0xf bank_mask:0xf
    v_dot2c_f32_bf16 v61, v214, v14
    v_dot2c_f32_bf16 v61, v215, v15
    v_max_f32 v41, v41, v60
    s_waitcnt vmcnt(11)
    s_cbranch_scc1 L_c48
    s_waitcnt vmcnt(7)
    s_cbranch_vccnz L_c48
    s_waitcnt vmcnt(4)
L_c48:
    buffer_load_dwordx4 v[180:183], v1, s[40:43], s60 offen offset:256 nt
    v_dot2c_f32_bf16 v61, v216, v16
    v_dot2c_f32_bf16 v61, v217, v17
    v_dot2c_f32_bf16 v61, v218, v18
    v_dot2c_f32_bf16 v61, v219, v19
    v_dot2c_f32_bf16 v62, v220, v8
    v_dot2c_f32_bf16 v62, v221, v9
    s_nop 0
    v_add_f32_dpp v61, v61, v61 quad_perm:[1,0,3,2] row_mask:0xf bank_mask:0xf
    v_dot2c_f32_bf16 v62, v222, v10
    v_dot2c_f32_bf16 v62, v223, v11
    v_add_f32_dpp v61, v61, v61 quad_perm:[2,3,0,1] row_mask:0xf bank_mask:0xf
    s_waitcnt vmcnt(11)
    s_cbranch_scc1 L_c49
    s_waitcnt vmcnt(7)
    s_cbranch_vccnz L_c49
    s_waitcnt vmcnt(4)
L_c49:
    s_mov_b64 exec, 1
    s_waitcnt lgkmcnt(0)
    v_cmp_lt_i32 vcc, 65, v55
    v_readfirstlane_b32 s8, v55
    ds_add_rtn_u32 v55, v53, v54 offset:6556
    s_mov_b64 exec, -1
    s_add_u32 s60, s60, 12288
    s_cmp_eq_u32 s60, 393216
    s_cselect_b32 s60, 0, s60
    s_cmp_gt_i32 s8, 67
    buffer_load_dwordx4 v[184:187], v1, s[40:43], s60 offen offset:0 nt
    v_dot2c_f32_bf16 v62, v224, v12
    v_dot2c_f32_bf16 v62, v225, v13
    v_add_f32_dpp v61, v61, v61 row_half_mirror row_mask:0xf bank_mask:0xf
    v_dot2c_f32_bf16 v62, v226, v14
    v_dot2c_f32_bf16 v62, v227, v15
    v_max_f32 v41, v41, v61
    v_dot2c_f32_bf16 v62, v228, v16
    v_dot2c_f32_bf16 v62, v229, v17
    v_dot2c_f32_bf16 v62, v230, v18
    v_dot2c_f32_bf16 v62, v231, v19
    s_waitcnt vmcnt(11)
    s_cbranch_scc1 L_c50
    s_waitcnt vmcnt(7)
    s_cbranch_vccnz L_c50
    s_waitcnt vmcnt(4)
L_c50:
    buffer_load_dwordx4 v[188:191], v1, s[40:43], s60 offen offset:128 nt
    v_dot2c_f32_bf16 v63, v232, v8
    v_dot2c_f32_bf16 v63, v233, v9
    v_add_f32_dpp v62, v62, v62 quad_perm:[1,0,3,2] row_mask:0xf bank_mask:0xf
    v_dot2c_f32_bf16 v63, v234, v10
    v_dot2c_f32_bf16 v63, v235, v11
    v_add_f32_dpp v62, v62, v62 quad_perm:[2,3,0,1] row_mask:0xf bank_mask:0xf
    v_dot2c_f32_bf16 v63, v236, v12
    v_dot2c_f32_bf16 v63, v237, v13
    v_add_f32_dpp v62, v62, v62 row_half_mirror row_mask:0xf bank_mask:0xf
    v_dot2c_f32_bf16 v63, v238, v14
    v_dot2c_f32_bf16 v63, v239, v15
    v_max_f32 v41, v41, v62
    s_waitcnt vmcnt(11)
    s_cbranch_scc1 L_c51
    s_waitcnt vmcnt(7)
    s_cbranch_vccnz L_c51
    s_waitcnt vmcnt(4)
L_c51:
    buffer_load_dwordx4 v[192:195], v1, s[40:43], s60 offen offset:256 nt
    v_dot2c_f32_bf16 v63, v240, v16
    v_dot2c_f32_bf16 v63, v241, v17
    v_dot2c_f32_bf16 v63, v242, v18
    v_dot2c_f32_bf16 v63, v243, v19
    v_dot2c_f32_bf16 v64, v244, v8
    v_dot2c_f32_bf16 v64, v245, v9
    s_nop 0
    v_add_f32_dpp v63, v63, v63 quad_perm:[1,0,3,2] row_mask:0xf bank_mask:0xf
    v_dot2c_f32_bf16 v64, v246, v10
    v_dot2c_f32_bf16 v64, v247, v11
    v_add_f32_dpp v63, v63, v63 quad_perm:[2,3,0,1] row_mask:0xf bank_mask:0xf
    s_waitcnt vmcnt(11)
    s_cbranch_scc1 L_c52
    s_waitcnt vmcnt(7)
    s_cbranch_vccnz L_c52
    s_waitcnt vmcnt(4)
L_c52:
    s_mov_b64 exec, 1
    s_waitcnt lgkmcnt(0)
    v_cmp_lt_i32 vcc, 69, v55
    v_readfirstlane_b32 s8, v55
    ds_add_rtn_u32 v55, v53, v54 offset:6556
    s_mov_b64 exec, -1
    s_add_u32 s60, s60, 12288
    s_cmp_eq_u32 s60, 393216
    s_cselect_b32 s60, 0, s60
    s_cmp_gt_i32 s8, 71
    buffer_load_dwordx4 v[196:199], v1, s[40:43], s60 offen offset:0 nt
    v_dot2c_f32_bf16 v64, v248, v12
    v_dot2c_f32_bf16 v64, v249, v13
    v_add_f32_dpp v63, v63, v63 row_half_mirror row_mask:0xf bank_mask:0xf
    v_dot2c_f32_bf16 v64, v250, v14
    v_dot2c_f32_bf16 v64, v251, v15
    v_max_f32 v41, v41, v63
    v_dot2c_f32_bf16 v64, v252, v16
    v_dot2c_f32_bf16 v64, v253, v17
    v_dot2c_f32_bf16 v64, v254, v18
    v_dot2c_f32_bf16 v64, v255, v19
    s_waitcnt vmcnt(11)
    s_cbranch_scc1 L_c53
    s_waitcnt vmcnt(7)
    s_cbranch_vccnz L_c53
    s_waitcnt vmcnt(4)
L_c53:
    buffer_load_dwordx4 v[200:203], v1, s[40:43], s60 offen offset:128 nt
    v_dot2c_f32_bf16 v65, v88, v8
    v_dot2c_f32_bf16 v65, v89, v9
    v_add_f32_dpp v64, v64, v64 quad_perm:[1,0,3,2] row_mask:0xf bank_mask:0xf
    v_dot2c_f32_bf16 v65, v90, v10
    v_dot2c_f32_bf16 v65, v91, v11
    v_add_f32_dpp v64, v64, v64 quad_perm:[2,3,0,1] row_mask:0xf bank_mask:0xf
    v_dot2c_f32_bf16 v65, v92, v12
    v_dot2c_f32_bf16 v65, v93, v13
    v_add_f32_dpp v64, v64, v64 row_half_mirror row_mask:0xf bank_mask:0xf
    v_dot2c_f32_bf16 v65, v94, v14
    v_dot2c_f32_bf16 v65, v95, v15
    v_max_f32 v41, v41, v64
    s_waitcnt vmcnt(11)
    s_cbranch_scc1 L_c54
    s_waitcnt vmcnt(7)
    s_cbranch_vccnz L_c54
    s_waitcnt vmcnt(4)
L_c54:
    buffer_load_dwordx4 v[204:207], v1, s[40:43], s60 offen offset:256 nt
    v_dot2c_f32_bf16 v65, v96, v16
    v_dot2c_f32_bf16 v65, v97, v17
    v_dot2c_f32_bf16 v65, v98, v18
    v_dot2c_f32_bf16 v65, v99, v19
    v_dot2c_f32_bf16 v66, v100, v8
    v_dot2c_f32_bf16 v66, v101, v9
    s_nop 0
    v_add_f32_dpp v65, v65, v65 quad_perm:[1,0,3,2] row_mask:0xf bank_mask:0xf
    v_dot2c_f32_bf16 v66, v102, v10
    v_dot2c_f32_bf16 v66, v103, v11
    v_add_f32_dpp v65, v65, v65 quad_perm:[2,3,0,1] row_mask:0xf bank_mask:0xf
    s_waitcnt vmcnt(11)
    s_cbranch_scc1 L_c55
    s_waitcnt vmcnt(7)
    s_cbranch_vccnz L_c55
    s_waitcnt vmcnt(4)
L_c55:
    s_mov_b64 exec, 1
    s_waitcnt lgkmcnt(0)
    v_cmp_lt_i32 vcc, 73, v55
    v_readfirstlane_b32 s8, v55
    ds_add_rtn_u32 v55, v53, v54 offset:6556
    s_mov_b64 exec, -1
    s_add_u32 s60, s60, 12288
    s_cmp_eq_u32 s60, 393216
    s_cselect_b32 s60, 0, s60
    s_cmp_gt_i32 s8, 75
    buffer_load_dwordx4 v[208:211], v1, s[40:43], s60 offen offset:0 nt
    v_dot2c_f32_bf16 v66, v104, v12
    v_dot2c_f32_bf16 v66, v105, v13
    v_add_f32_dpp v65, v65, v65 row_half_mirror row_mask:0xf bank_mask:0xf
    v_dot2c_f32_bf16 v66, v106, v14
    v_dot2c_f32_bf16 v66, v107, v15
    v_max_f32 v41, v41, v65
    v_dot2c_f32_bf16 v66, v108, v16
    v_dot2c_f32_bf16 v66, v109, v17
    v_dot2c_f32_bf16 v66, v110, v18
    v_dot2c_f32_bf16 v66, v111, v19
    s_waitcnt vmcnt(11)
    s_cbranch_scc1 L_c56
    s_waitcnt vmcnt(7)
    s_cbranch_vccnz L_c56
    s_waitcnt vmcnt(4)
L_c56:
    buffer_load_dwordx4 v[212:215], v1, s[40:43], s60 offen offset:128 nt
    v_dot2c_f32_bf16 v67, v112, v8
    v_dot2c_f32_bf16 v67, v113, v9
    v_add_f32_dpp v66, v66, v66 quad_perm:[1,0,3,2] row_mask:0xf bank_mask:0xf
    v_dot2c_f32_bf16 v67, v114, v10
    v_dot2c_f32_bf16 v67, v115, v11
    v_add_f32_dpp v66, v66, v66 quad_perm:[2,3,0,1] row_mask:0xf bank_mask:0xf
    v_dot2c_f32_bf16 v67, v116, v12
    v_dot2c_f32_bf16 v67, v117, v13
    v_add_f32_dpp v66, v66, v66 row_half_mirror row_mask:0xf bank_mask:0xf
    v_dot2c_f32_bf16 v67, v118, v14
    v_dot2c_f32_bf16 v67, v119, v15
    v_max_f32 v41, v41, v66
    s_waitcnt vmcnt(11)
    s_cbranch_scc1 L_c57
    s_waitcnt vmcnt(7)
    s_cbranch_vccnz L_c57
    s_waitcnt vmcnt(4)
L_c57:
    buffer_load_dwordx4 v[216:219], v1, s[40:43], s60 offen offset:256 nt
    v_dot2c_f32_bf16 v67, v120, v16
    v_dot2c_f32_bf16 v67, v121, v17
    v_dot2c_f32_bf16 v67, v122, v18
    v_dot2c_f32_bf16 v67, v123, v19
    v_dot2c_f32_bf16 v68, v124, v8
    v_dot2c_f32_bf16 v68, v125, v9
    s_nop 0
    v_add_f32_dpp v67, v67, v67 quad_perm:[1,0,3,2] row_mask:0xf bank_mask:0xf
    v_dot2c_f32_bf16 v68, v126, v10
    v_dot2c_f32_bf16 v68, v127, v11
    v_add_f32_dpp v67, v67, v67 quad_perm:[2,3,0,1] row_mask:0xf bank_mask:0xf
    s_waitcnt vmcnt(11)
    s_cbranch_scc1 L_c58
    s_waitcnt vmcnt(7)
    s_cbranch_vccnz L_c58
    s_waitcnt vmcnt(4)
L_c58:
    s_mov_b64 exec, 1
    s_waitcnt lgkmcnt(0)
    v_cmp_lt_i32 vcc, 77, v55
    v_readfirstlane_b32 s8, v55
    ds_add_rtn_u32 v55, v53, v54 offset:6556
    s_mov_b64 exec, -1
    s_add_u32 s60, s60, 12288
    s_cmp_eq_u32 s60, 393216
    s_cselect_b32 s60, 0, s60
    s_cmp_gt_i32 s8, 79
    buffer_load_dwordx4 v[220:223], v1, s[40:43], s60 offen offset:0 nt
    v_dot2c_f32_bf16 v68, v128, v12
    v_dot2c_f32_bf16 v68, v129, v13
    v_add_f32_dpp v67, v67, v67 row_half_mirror row_mask:0xf bank_mask:0xf
    v_dot2c_f32_bf16 v68, v130, v14
    v_dot2c_f32_bf16 v68, v131, v15
    v_max_f32 v41, v41, v67
    v_dot2c_f32_bf16 v68, v132, v16
    v_dot2c_f32_bf16 v68, v133, v17
    v_dot2c_f32_bf16 v68, v134, v18
    v_dot2c_f32_bf16 v68, v135, v19
    s_waitcnt vmcnt(11)
    s_cbranch_scc1 L_c59
    s_waitcnt vmcnt(7)
    s_cbranch_vccnz L_c59
    s_waitcnt vmcnt(4)
L_c59:
    buffer_load_dwordx4 v[224:227], v1, s[40:43], s60 offen offset:128 nt
    v_dot2c_f32_bf16 v69, v136, v8
    v_dot2c_f32_bf16 v69, v137, v9
    v_add_f32_dpp v68, v68, v68 quad_perm:[1,0,3,2] row_mask:0xf bank_mask:0xf
    v_dot2c_f32_bf16 v69, v138, v10
    v_dot2c_f32_bf16 v69, v139, v11
    v_add_f32_dpp v68, v68, v68 quad_perm:[2,3,0,1] row_mask:0xf bank_mask:0xf
    v_dot2c_f32_bf16 v69, v140, v12
    v_dot2c_f32_bf16 v69, v141, v13
    v_add_f32_dpp v68, v68, v68 row_half_mirror row_mask:0xf bank_mask:0xf
    v_dot2c_f32_bf16 v69, v142, v14
    v_dot2c_f32_bf16 v69, v143, v15
    v_max_f32 v41, v41, v68
    s_waitcnt vmcnt(11)
    s_cbranch_scc1 L_c60
    s_waitcnt vmcnt(7)
    s_cbranch_vccnz L_c60
    s_waitcnt vmcnt(4)
L_c60:
    buffer_load_dwordx4 v[228:231], v1, s[40:43], s60 offen offset:256 nt
    v_dot2c_f32_bf16 v69, v144, v16
    v_dot2c_f32_bf16 v69, v145, v17
    v_dot2c_f32_bf16 v69, v146, v18
    v_dot2c_f32_bf16 v69, v147, v19
    v_dot2c_f32_bf16 v70, v148, v8
    v_dot2c_f32_bf16 v70, v149, v9
    s_nop 0
    v_add_f32_dpp v69, v69, v69 quad_perm:[1,0,3,2] row_mask:0xf bank_mask:0xf
    v_dot2c_f32_bf16 v70, v150, v10
    v_dot2c_f32_bf16 v70, v151, v11
    v_add_f32_dpp v69, v69, v69 quad_perm:[2,3,0,1] row_mask:0xf bank_mask:0xf
    s_waitcnt vmcnt(11)
    s_cbranch_scc1 L_c61
    s_waitcnt vmcnt(7)
    s_cbranch_vccnz L_c61
    s_waitcnt vmcnt(4)
L_c61:
    s_mov_b64 exec, 1
    s_waitcnt lgkmcnt(0)
    v_cmp_lt_i32 vcc, 81, v55
    v_readfirstlane_b32 s8, v55
    ds_add_rtn_u32 v55, v53, v54 offset:6556
    s_mov_b64 exec, -1
    s_add_u32 s60, s60, 12288
    s_cmp_eq_u32 s60, 393216
    s_cselect_b32 s60, 0, s60
    s_cmp_gt_i32 s8, 83
    buffer_load_dwordx4 v[232:235], v1, s[40:43], s60 offen offset:0 nt
    v_dot2c_f32_bf16 v70, v152, v12
    v_dot2c_f32_bf16 v70, v153, v13
    v_add_f32_dpp v69, v69, v69 row_half_mirror row_mask:0xf bank_mask:0xf
    v_dot2c_f32_bf16 v70, v154, v14
    v_dot2c_f32_bf16 v70, v155, v15
    v_max_f32 v41, v41, v69
    v_dot2c_f32_bf16 v70, v156, v16
    v_dot2c_f32_bf16 v70, v157, v17
    v_dot2c_f32_bf16 v70, v158, v18
    v_dot2c_f32_bf16 v70, v159, v19
    s_waitcnt vmcnt(11)
    s_cbranch_scc1 L_c62
    s_waitcnt vmcnt(7)
    s_cbranch_vccnz L_c62
    s_waitcnt vmcnt(4)
L_c62:
    buffer_load_dwordx4 v[236:239], v1, s[40:43], s60 offen offset:128 nt
    v_dot2c_f32_bf16 v71, v160, v8
    v_dot2c_f32_bf16 v71, v161, v9
    v_add_f32_dpp v70, v70, v70 quad_perm:[1,0,3,2] row_mask:0xf bank_mask:0xf
    v_dot2c_f32_bf16 v71, v162, v10
    v_dot2c_f32_bf16 v71, v163, v11
    v_add_f32_dpp v70, v70, v70 quad_perm:[2,3,0,1] row_mask:0xf bank_mask:0xf
    v_dot2c_f32_bf16 v71, v164, v12
    v_dot2c_f32_bf16 v71, v165, v13
    v_add_f32_dpp v70, v70, v70 row_half_mirror row_mask:0xf bank_mask:0xf
    v_dot2c_f32_bf16 v71, v166, v14
    v_dot2c_f32_bf16 v71, v167, v15
    v_max_f32 v41, v41, v70
    s_waitcnt vmcnt(11)
    s_cbranch_scc1 L_c63
    s_waitcnt vmcnt(7)
    s_cbranch_vccnz L_c63
    s_waitcnt vmcnt(4)
L_c63:
    buffer_load_dwordx4 v[240:243], v1, s[40:43], s60 offen offset:256 nt
    v_dot2c_f32_bf16 v71, v168, v16
    v_dot2c_f32_bf16 v71, v169, v17
    v_dot2c_f32_bf16 v71, v170, v18
    v_dot2c_f32_bf16 v71, v171, v19
    v_dot2c_f32_bf16 v72, v172, v8
    v_dot2c_f32_bf16 v72, v173, v9
    s_nop 0
    v_add_f32_dpp v71, v71, v71 quad_perm:[1,0,3,2] row_mask:0xf bank_mask:0xf
    v_dot2c_f32_bf16 v72, v174, v10
    v_dot2c_f32_bf16 v72, v175, v11
    v_add_f32_dpp v71, v71, v71 quad_perm:[2,3,0,1] row_mask:0xf bank_mask:0xf
    s_waitcnt vmcnt(11)
    s_cbranch_scc1 L_c64
    s_waitcnt vmcnt(7)
    s_cbranch_vccnz L_c64
    s_waitcnt vmcnt(4)
L_c64:
    s_mov_b64 exec, 1
    s_waitcnt lgkmcnt(0)
    v_cmp_lt_i32 vcc, 85, v55
    v_readfirstlane_b32 s8, v55
    ds_add_rtn_u32 v55, v53, v54 offset:6556
    s_mov_b64 exec, -1
    s_add_u32 s60, s60, 12288
    s_cmp_eq_u32 s60, 393216
    s_cselect_b32 s60, 0, s60
    s_cmp_gt_i32 s8, 87
    buffer_load_dwordx4 v[244:247], v1, s[40:43], s60 offen offset:0 nt
    v_dot2c_f32_bf16 v72, v176, v12
    v_dot2c_f32_bf16 v72, v177, v13
    v_add_f32_dpp v71, v71, v71 row_half_mirror row_mask:0xf bank_mask:0xf
    v_dot2c_f32_bf16 v72, v178, v14
    v_dot2c_f32_bf16 v72, v179, v15
    v_max_f32 v41, v41, v71
    v_dot2c_f32_bf16 v72, v180, v16
    v_dot2c_f32_bf16 v72, v181, v17
    v_dot2c_f32_bf16 v72, v182, v18
    v_dot2c_f32_bf16 v72, v183, v19
    s_waitcnt vmcnt(11)
    s_cbranch_scc1 L_c65
    s_waitcnt vmcnt(7)
    s_cbranch_vccnz L_c65
    s_waitcnt vmcnt(4)
L_c65:
    buffer_load_dwordx4 v[248:251], v1, s[40:43], s60 offen offset:128 nt
    v_dot2c_f32_bf16 v73, v184, v8
    v_dot2c_f32_bf16 v73, v185, v9
    v_add_f32_dpp v72, v72, v72 quad_perm:[1,0,3,2] row_mask:0xf bank_mask:0xf
    v_dot2c_f32_bf16 v73, v186, v10
    v_dot2c_f32_bf16 v73, v187, v11
    v_add_f32_dpp v72, v72, v72 quad_perm:[2,3,0,1] row_mask:0xf bank_mask:0xf
    v_dot2c_f32_bf16 v73, v188, v12
    v_dot2c_f32_bf16 v73, v189, v13
    v_add_f32_dpp v72, v72, v72 row_half_mirror row_mask:0xf bank_mask:0xf
    v_dot2c_f32_bf16 v73, v190, v14
    v_dot2c_f32_bf16 v73, v191, v15
    v_max_f32 v41, v41, v72
    s_waitcnt vmcnt(11)
    s_cbranch_scc1 L_c66
    s_waitcnt vmcnt(7)
    s_cbranch_vccnz L_c66
    s_waitcnt vmcnt(4)
L_c66:
    buffer_load_dwordx4 v[252:255], v1, s[40:43], s60 offen offset:256 nt
    v_dot2c_f32_bf16 v73, v192, v16
    v_dot2c_f32_bf16 v73, v193, v17
    v_dot2c_f32_bf16 v73, v194, v18
    v_dot2c_f32_bf16 v73, v195, v19
    v_dot2c_f32_bf16 v74, v196, v8
    v_dot2c_f32_bf16 v74, v197, v9
    s_nop 0
    v_add_f32_dpp v73, v73, v73 quad_perm:[1,0,3,2] row_mask:0xf bank_mask:0xf
    v_dot2c_f32_bf16 v74, v198, v10
    v_dot2c_f32_bf16 v74, v199, v11
    v_add_f32_dpp v73, v73, v73 quad_perm:[2,3,0,1] row_mask:0xf bank_mask:0xf
    s_waitcnt vmcnt(11)
    s_cbranch_scc1 L_c67
    s_waitcnt vmcnt(7)
    s_cbranch_vccnz L_c67
    s_waitcnt vmcnt(4)
L_c67:
    s_mov_b64 exec, 1
    s_waitcnt lgkmcnt(0)
    v_cmp_lt_i32 vcc, 89, v55
    v_readfirstlane_b32 s8, v55
    ds_add_rtn_u32 v55, v53, v54 offset:6556
    s_mov_b64 exec, -1
    s_add_u32 s60, s60, 12288
    s_cmp_eq_u32 s60, 393216
    s_cselect_b32 s60, 0, s60
    s_cmp_gt_i32 s8, 91
    buffer_load_dwordx4 v[88:91], v1, s[40:43], s60 offen offset:0 nt
    v_dot2c_f32_bf16 v74, v200, v12
    v_dot2c_f32_bf16 v74, v201, v13
    v_add_f32_dpp v73, v73, v73 row_half_mirror row_mask:0xf bank_mask:0xf
    v_dot2c_f32_bf16 v74, v202, v14
    v_dot2c_f32_bf16 v74, v203, v15
    v_max_f32 v41, v41, v73
    v_dot2c_f32_bf16 v74, v204, v16
    v_dot2c_f32_bf16 v74, v205, v17
    v_dot2c_f32_bf16 v74, v206, v18
    v_dot2c_f32_bf16 v74, v207, v19
    s_waitcnt vmcnt(11)
    s_cbranch_scc1 L_c68
    s_waitcnt vmcnt(7)
    s_cbranch_vccnz L_c68
    s_waitcnt vmcnt(4)
L_c68:
    buffer_load_dwordx4 v[92:95], v1, s[40:43], s60 offen offset:128 nt
    v_dot2c_f32_bf16 v75, v208, v8
    v_dot2c_f32_bf16 v75, v209, v9
    v_add_f32_dpp v74, v74, v74 quad_perm:[1,0,3,2] row_mask:0xf bank_mask:0xf
    v_dot2c_f32_bf16 v75, v210, v10
    v_dot2c_f32_bf16 v75, v211, v11
    v_add_f32_dpp v74, v74, v74 quad_perm:[2,3,0,1] row_mask:0xf bank_mask:0xf
    v_dot2c_f32_bf16 v75, v212, v12
    v_dot2c_f32_bf16 v75, v213, v13
    v_add_f32_dpp v74, v74, v74 row_half_mirror row_mask:0xf bank_mask:0xf
    v_dot2c_f32_bf16 v75, v214, v14
    v_dot2c_f32_bf16 v75, v215, v15
    v_max_f32 v41, v41, v74
    s_waitcnt vmcnt(11)
    s_cbranch_scc1 L_c69
    s_waitcnt vmcnt(7)
    s_cbranch_vccnz L_c69
    s_waitcnt vmcnt(4)
L_c69:
    buffer_load_dwordx4 v[96:99], v1, s[40:43], s60 offen offset:256 nt
    v_dot2c_f32_bf16 v75, v216, v16
    v_dot2c_f32_bf16 v75, v217, v17
    v_dot2c_f32_bf16 v75, v218, v18
    v_dot2c_f32_bf16 v75, v219, v19
    s_waitcnt vmcnt(11)
    s_cbranch_scc1 L_c70
    s_waitcnt vmcnt(7)
    s_cbranch_vccnz L_c70
    s_waitcnt vmcnt(4)
L_c70:
    s_mov_b64 exec, 1
    s_waitcnt lgkmcnt(0)
    v_cmp_lt_i32 vcc, 93, v55
    v_readfirstlane_b32 s8, v55
    ds_add_rtn_u32 v55, v53, v54 offset:6556
    s_mov_b64 exec, -1
    s_add_u32 s60, s60, 12288
    s_cmp_eq_u32 s60, 393216
    s_cselect_b32 s60, 0, s60
    s_cmp_gt_i32 s8, 95
    buffer_load_dwordx4 v[100:103], v1, s[40:43], s60 offen offset:0 nt
    v_dot2c_f32_bf16 v76, v220, v8
    v_dot2c_f32_bf16 v76, v221, v9
    v_add_f32_dpp v75, v75, v75 quad_perm:[1,0,3,2] row_mask:0xf bank_mask:0xf
    v_dot2c_f32_bf16 v76, v222, v10
    v_dot2c_f32_bf16 v76, v223, v11
    v_add_f32_dpp v75, v75, v75 quad_perm:[2,3,0,1] row_mask:0xf bank_mask:0xf
    s_waitcnt vmcnt(11)
    s_cbranch_scc1 L_c71
    s_waitcnt vmcnt(7)
    s_cbranch_vccnz L_c71
    s_waitcnt vmcnt(4)
L_c71:
    buffer_load_dwordx4 v[104:107], v1, s[40:43], s60 offen offset:128 nt
    v_dot2c_f32_bf16 v76, v224, v12
    v_dot2c_f32_bf16 v76, v225, v13
    v_add_f32_dpp v75, v75, v75 row_half_mirror row_mask:0xf bank_mask:0xf
    v_dot2c_f32_bf16 v76, v226, v14
    v_dot2c_f32_bf16 v76, v227, v15
    v_max_f32 v41, v41, v75
    s_waitcnt vmcnt(11)
    s_cbranch_scc1 L_c72
    s_waitcnt vmcnt(7)
    s_cbranch_vccnz L_c72
    s_waitcnt vmcnt(4)
L_c72:
    buffer_load_dwordx4 v[108:111], v1, s[40:43], s60 offen offset:256 nt
    v_dot2c_f32_bf16 v76, v228, v16
    v_dot2c_f32_bf16 v76, v229, v17
    v_dot2c_f32_bf16 v76, v230, v18
    v_dot2c_f32_bf16 v76, v231, v19
    s_waitcnt vmcnt(11)
    s_cbranch_scc1 L_c73
    s_waitcnt vmcnt(7)
    s_cbranch_vccnz L_c73
    s_waitcnt vmcnt(4)
L_c73:
    s_mov_b64 exec, 1
    s_waitcnt lgkmcnt(0)
    v_cmp_lt_i32 vcc, 97, v55
    v_readfirstlane_b32 s8, v55
    ds_add_rtn_u32 v55, v53, v54 offset:6556
    s_mov_b64 exec, -1
    s_add_u32 s60, s60, 12288
    s_cmp_eq_u32 s60, 393216
    s_cselect_b32 s60, 0, s60
    s_cmp_gt_i32 s8, 99
    buffer_load_dwordx4 v[112:115], v1, s[40:43], s60 offen offset:0 nt
    v_dot2c_f32_bf16 v77, v232, v8
    v_dot2c_f32_bf16 v77, v233, v9
    v_add_f32_dpp v76, v76, v76 quad_perm:[1,0,3,2] row_mask:0xf bank_mask:0xf
    v_dot2c_f32_bf16 v77, v234, v10
    v_dot2c_f32_bf16 v77, v235, v11
    v_add_f32_dpp v76, v76, v76 quad_perm:[2,3,0,1] row_mask:0xf bank_mask:0xf
    s_waitcnt vmcnt(11)
    s_cbranch_scc1 L_c74
    s_waitcnt vmcnt(7)
    s_cbranch_vccnz L_c74
    s_waitcnt vmcnt(4)
L_c74:
    buffer_load_dwordx4 v[116:119], v1, s[40:43], s60 offen offset:128 nt
    v_dot2c_f32_bf16 v77, v236, v12
    v_dot2c_f32_bf16 v77, v237, v13
    v_add_f32_dpp v76, v76, v76 row_half_mirror row_mask:0xf bank_mask:0xf
    v_dot2c_f32_bf16 v77, v238, v14
    v_dot2c_f32_bf16 v77, v239, v15
    v_max_f32 v41, v41, v76
    s_waitcnt vmcnt(11)
    s_cbranch_scc1 L_c75
    s_waitcnt vmcnt(7)
    s_cbranch_vccnz L_c75
    s_waitcnt vmcnt(4)
L_c75:
    buffer_load_dwordx4 v[120:123], v1, s[40:43], s60 offen offset:256 nt
    v_dot2c_f32_bf16 v77, v240, v16
    v_dot2c_f32_bf16 v77, v241, v17
    v_dot2c_f32_bf16 v77, v242, v18
    v_dot2c_f32_bf16 v77, v243, v19
    s_waitcnt vmcnt(11)
    s_cbranch_scc1 L_c76
    s_waitcnt vmcnt(7)
    s_cbranch_vccnz L_c76
    s_waitcnt vmcnt(4)
L_c76:
    s_mov_b64 exec, 1
    s_waitcnt lgkmcnt(0)
    v_cmp_lt_i32 vcc, 101, v55
    v_readfirstlane_b32 s8, v55
    ds_add_rtn_u32 v55, v53, v54 offset:6556
    s_mov_b64 exec, -1
    s_add_u32 s60, s60, 12288
    s_cmp_eq_u32 s60, 393216
    s_cselect_b32 s60, 0, s60
    s_cmp_gt_i32 s8, 103
    buffer_load_dwordx4 v[124:127], v1, s[40:43], s60 offen offset:0 nt
    v_dot2c_f32_bf16 v78, v244, v8
    v_dot2c_f32_bf16 v78, v245, v9
    v_add_f32_dpp v77, v77, v77 quad_perm:[1,0,3,2] row_mask:0xf bank_mask:0xf
    v_dot2c_f32_bf16 v78, v246, v10
    v_dot2c_f32_bf16 v78, v247, v11
    v_add_f32_dpp v77, v77, v77 quad_perm:[2,3,0,1] row_mask:0xf bank_mask:0xf
    s_waitcnt vmcnt(11)
    s_cbranch_scc1 L_c77
    s_waitcnt vmcnt(7)
    s_cbranch_vccnz L_c77
    s_waitcnt vmcnt(4)
L_c77:
    buffer_load_dwordx4 v[128:131], v1, s[40:43], s60 offen offset:128 nt
    v_dot2c_f32_bf16 v78, v248, v12
    v_dot2c_f32_bf16 v78, v249, v13
    v_add_f32_dpp v77, v77, v77 row_half_mirror row_mask:0xf bank_mask:0xf
    v_dot2c_f32_bf16 v78, v250, v14
    v_dot2c_f32_bf16 v78, v251, v15
    v_max_f32 v41, v41, v77
    s_waitcnt vmcnt(11)
    s_cbranch_scc1 L_c78
    s_waitcnt vmcnt(7)
    s_cbranch_vccnz L_c78
    s_waitcnt vmcnt(4)
L_c78:
    buffer_load_dwordx4 v[132:135], v1, s[40:43], s60 offen offset:256 nt
    v_dot2c_f32_bf16 v78, v252, v16
    v_dot2c_f32_bf16 v78, v253, v17
    v_dot2c_f32_bf16 v78, v254, v18
    v_dot2c_f32_bf16 v78, v255, v19
    s_waitcnt vmcnt(11)
    s_cbranch_scc1 L_c79
    s_waitcnt vmcnt(7)
    s_cbranch_vccnz L_c79
    s_waitcnt vmcnt(4)
L_c79:
    s_mov_b64 exec, 1
    s_waitcnt lgkmcnt(0)
    v_cmp_lt_i32 vcc, 105, v55
    v_readfirstlane_b32 s8, v55
    ds_add_rtn_u32 v55, v53, v54 offset:6556
    s_mov_b64 exec, -1
    s_add_u32 s60, s60, 12288
    s_cmp_eq_u32 s60, 393216
    s_cselect_b32 s60, 0, s60
    s_cmp_gt_i32 s8, 107
    buffer_load_dwordx4 v[136:139], v1, s[40:43], s60 offen offset:0 nt
    v_dot2c_f32_bf16 v79, v88, v8
    v_dot2c_f32_bf16 v79, v89, v9
    v_add_f32_dpp v78, v78, v78 quad_perm:[1,0,3,2] row_mask:0xf bank_mask:0xf
    v_dot2c_f32_bf16 v79, v90, v10
    v_dot2c_f32_bf16 v79, v91, v11
    v_add_f32_dpp v78, v78, v78 quad_perm:[2,3,0,1] row_mask:0xf bank_mask:0xf
    s_waitcnt vmcnt(11)
    s_cbranch_scc1 L_c80
    s_waitcnt vmcnt(7)
    s_cbranch_vccnz L_c80
    s_waitcnt vmcnt(4)
L_c80:
    buffer_load_dwordx4 v[140:143], v1, s[40:43], s60 offen offset:128 nt
    v_dot2c_f32_bf16 v79, v92, v12
    v_dot2c_f32_bf16 v79, v93, v13
    v_add_f32_dpp v78, v78, v78 row_half_mirror row_mask:0xf bank_mask:0xf
    v_dot2c_f32_bf16 v79, v94, v14
    v_dot2c_f32_bf16 v79, v95, v15
    v_max_f32 v41, v41, v78
    s_waitcnt vmcnt(11)
    s_cbranch_scc1 L_c81
    s_waitcnt vmcnt(7)
    s_cbranch_vccnz L_c81
    s_waitcnt vmcnt(4)
L_c81:
    buffer_load_dwordx4 v[144:147], v1, s[40:43], s60 offen offset:256 nt
    v_dot2c_f32_bf16 v79, v96, v16
    v_dot2c_f32_bf16 v79, v97, v17
    v_dot2c_f32_bf16 v79, v98, v18
    v_dot2c_f32_bf16 v79, v99, v19
    s_waitcnt vmcnt(11)
    s_cbranch_scc1 L_c82
    s_waitcnt vmcnt(7)
    s_cbranch_vccnz L_c82
    s_waitcnt vmcnt(4)
L_c82:
    s_mov_b64 exec, 1
    s_waitcnt lgkmcnt(0)
    v_cmp_lt_i32 vcc, 109, v55
    v_readfirstlane_b32 s8, v55
    ds_add_rtn_u32 v55, v53, v54 offset:6556
    s_mov_b64 exec, -1
    s_add_u32 s60, s60, 12288
    s_cmp_eq_u32 s60, 393216
    s_cselect_b32 s60, 0, s60
    s_cmp_gt_i32 s8, 111
    buffer_load_dwordx4 v[148:151], v1, s[40:43], s60 offen offset:0 nt
    v_dot2c_f32_bf16 v80, v100, v8
    v_dot2c_f32_bf16 v80, v101, v9
    v_add_f32_dpp v79, v79, v79 quad_perm:[1,0,3,2] row_mask:0xf bank_mask:0xf
    v_dot2c_f32_bf16 v80, v102, v10
    v_dot2c_f32_bf16 v80, v103, v11
    v_add_f32_dpp v79, v79, v79 quad_perm:[2,3,0,1] row_mask:0xf bank_mask:0xf
    s_waitcnt vmcnt(11)
    s_cbranch_scc1 L_c83
    s_waitcnt vmcnt(7)
    s_cbranch_vccnz L_c83
    s_waitcnt vmcnt(4)
L_c83:
    buffer_load_dwordx4 v[152:155], v1, s[40:43], s60 offen offset:128 nt
    v_dot2c_f32_bf16 v80, v104, v12
    v_dot2c_f32_bf16 v80, v105, v13
    v_add_f32_dpp v79, v79, v79 row_half_mirror row_mask:0xf bank_mask:0xf
    v_dot2c_f32_bf16 v80, v106, v14
    v_dot2c_f32_bf16 v80, v107, v15
    v_max_f32 v41, v41, v79
    s_waitcnt vmcnt(11)
    s_cbranch_scc1 L_c84
    s_waitcnt vmcnt(7)
    s_cbranch_vccnz L_c84
    s_waitcnt vmcnt(4)
L_c84:
    buffer_load_dwordx4 v[156:159], v1, s[40:43], s60 offen offset:256 nt
    v_dot2c_f32_bf16 v80, v108, v16
    v_dot2c_f32_bf16 v80, v109, v17
    v_dot2c_f32_bf16 v80, v110, v18
    v_dot2c_f32_bf16 v80, v111, v19
    s_waitcnt vmcnt(11)
    s_cbranch_scc1 L_c85
    s_waitcnt vmcnt(7)
    s_cbranch_vccnz L_c85
    s_waitcnt vmcnt(4)
L_c85:
    s_mov_b64 exec, 1
    s_waitcnt lgkmcnt(0)
    v_cmp_lt_i32 vcc, 113, v55
    v_readfirstlane_b32 s8, v55
    ds_add_rtn_u32 v55, v53, v54 offset:6556
    s_mov_b64 exec, -1
    s_add_u32 s60, s60, 12288
    s_cmp_eq_u32 s60, 393216
    s_cselect_b32 s60, 0, s60
    s_cmp_gt_i32 s8, 115
    buffer_load_dwordx4 v[160:163], v1, s[40:43], s60 offen offset:0 nt
    v_dot2c_f32_bf16 v81, v112, v8
    v_dot2c_f32_bf16 v81, v113, v9
    v_add_f32_dpp v80, v80, v80 quad_perm:[1,0,3,2] row_mask:0xf bank_mask:0xf
    v_dot2c_f32_bf16 v81, v114, v10
    v_dot2c_f32_bf16 v81, v115, v11
    v_add_f32_dpp v80, v80, v80 quad_perm:[2,3,0,1] row_mask:0xf bank_mask:0xf
    s_waitcnt vmcnt(11)
    s_cbranch_scc1 L_c86
    s_waitcnt vmcnt(7)
    s_cbranch_vccnz L_c86
    s_waitcnt vmcnt(4)
L_c86:
    buffer_load_dwordx4 v[164:167], v1, s[40:43], s60 offen offset:128 nt
    v_dot2c_f32_bf16 v81, v116, v12
    v_dot2c_f32_bf16 v81, v117, v13
    v_add_f32_dpp v80, v80, v80 row_half_mirror row_mask:0xf bank_mask:0xf
    v_dot2c_f32_bf16 v81, v118, v14
    v_dot2c_f32_bf16 v81, v119, v15
    v_max_f32 v41, v41, v80
    s_waitcnt vmcnt(11)
    s_cbranch_scc1 L_c87
    s_waitcnt vmcnt(7)
    s_cbranch_vccnz L_c87
    s_waitcnt vmcnt(4)
L_c87:
    buffer_load_dwordx4 v[168:171], v1, s[40:43], s60 offen offset:256 nt
    v_dot2c_f32_bf16 v81, v120, v16
    v_dot2c_f32_bf16 v81, v121, v17
    v_dot2c_f32_bf16 v81, v122, v18
    v_dot2c_f32_bf16 v81, v123, v19
    s_waitcnt vmcnt(11)
    s_cbranch_scc1 L_c88
    s_waitcnt vmcnt(7)
    s_cbranch_vccnz L_c88
    s_waitcnt vmcnt(4)
L_c88:
    s_mov_b64 exec, 1
    s_waitcnt lgkmcnt(0)
    v_cmp_lt_i32 vcc, 117, v55
    v_readfirstlane_b32 s8, v55
    ds_add_rtn_u32 v55, v53, v54 offset:6556
    s_mov_b64 exec, -1
    s_add_u32 s60, s60, 12288
    s_cmp_eq_u32 s60, 393216
    s_cselect_b32 s60, 0, s60
    s_cmp_gt_i32 s8, 119
    buffer_load_dwordx4 v[172:175], v1, s[40:43], s60 offen offset:0 nt
    v_dot2c_f32_bf16 v82, v124, v8
    v_dot2c_f32_bf16 v82, v125, v9
    v_add_f32_dpp v81, v81, v81 quad_perm:[1,0,3,2] row_mask:0xf bank_mask:0xf
    v_dot2c_f32_bf16 v82, v126, v10
    v_dot2c_f32_bf16 v82, v127, v11
    v_add_f32_dpp v81, v81, v81 quad_perm:[2,3,0,1] row_mask:0xf bank_mask:0xf
    s_waitcnt vmcnt(11)
    s_cbranch_scc1 L_c89
    s_waitcnt vmcnt(7)
    s_cbranch_vccnz L_c89
    s_waitcnt vmcnt(4)
L_c89:
    buffer_load_dwordx4 v[176:179], v1, s[40:43], s60 offen offset:128 nt
    v_dot2c_f32_bf16 v82, v128, v12
    v_dot2c_f32_bf16 v82, v129, v13
    v_add_f32_dpp v81, v81, v81 row_half_mirror row_mask:0xf bank_mask:0xf
    v_dot2c_f32_bf16 v82, v130, v14
    v_dot2c_f32_bf16 v82, v131, v15
    v_max_f32 v41, v41, v81
    s_waitcnt vmcnt(11)
    s_cbranch_scc1 L_c90
    s_waitcnt vmcnt(7)
    s_cbranch_vccnz L_c90
    s_waitcnt vmcnt(4)
L_c90:
    buffer_load_dwordx4 v[180:183], v1, s[40:43], s60 offen offset:256 nt
    v_dot2c_f32_bf16 v82, v132, v16
    v_dot2c_f32_bf16 v82, v133, v17
    v_dot2c_f32_bf16 v82, v134, v18
    v_dot2c_f32_bf16 v82, v135, v19
    s_waitcnt vmcnt(11)
    s_cbranch_scc1 L_c91
    s_waitcnt vmcnt(7)
    s_cbranch_vccnz L_c91
    s_waitcnt vmcnt(4)
L_c91:
    s_mov_b64 exec, 1
    s_waitcnt lgkmcnt(0)
    v_cmp_lt_i32 vcc, 121, v55
    v_readfirstlane_b32 s8, v55
    ds_add_rtn_u32 v55, v53, v54 offset:6556
    s_mov_b64 exec, -1
    s_add_u32 s60, s60, 12288
    s_cmp_eq_u32 s60, 393216
    s_cselect_b32 s60, 0, s60
    s_cmp_gt_i32 s8, 123
    buffer_load_dwordx4 v[184:187], v1, s[40:43], s60 offen offset:0 nt
    v_dot2c_f32_bf16 v83, v136, v8
    v_dot2c_f32_bf16 v83, v137, v9
    v_add_f32_dpp v82, v82, v82 quad_perm:[1,0,3,2] row_mask:0xf bank_mask:0xf
    v_dot2c_f32_bf16 v83, v138, v10
    v_dot2c_f32_bf16 v83, v139, v11
    v_add_f32_dpp v82, v82, v82 quad_perm:[2,3,0,1] row_mask:0xf bank_mask:0xf
    s_waitcnt vmcnt(11)
    s_cbranch_scc1 L_c92
    s_waitcnt vmcnt(7)
    s_cbranch_vccnz L_c92
    s_waitcnt vmcnt(4)
L_c92:
    buffer_load_dwordx4 v[188:191], v1, s[40:43], s60 offen offset:128 nt
    v_dot2c_f32_bf16 v83, v140, v12
    v_dot2c_f32_bf16 v83, v141, v13
    v_add_f32_dpp v82, v82, v82 row_half_mirror row_mask:0xf bank_mask:0xf
    v_dot2c_f32_bf16 v83, v142, v14
    v_dot2c_f32_bf16 v83, v143, v15
    v_max_f32 v41, v41, v82
    s_waitcnt vmcnt(11)
    s_cbranch_scc1 L_c93
    s_waitcnt vmcnt(7)
    s_cbranch_vccnz L_c93
    s_waitcnt vmcnt(4)
L_c93:
    buffer_load_dwordx4 v[192:195], v1, s[40:43], s60 offen offset:256 nt
    v_dot2c_f32_bf16 v83, v144, v16
    v_dot2c_f32_bf16 v83, v145, v17
    v_dot2c_f32_bf16 v83, v146, v18
    v_dot2c_f32_bf16 v83, v147, v19
    s_waitcnt vmcnt(11)
    s_cbranch_scc1 L_c94
    s_waitcnt vmcnt(7)
    s_cbranch_vccnz L_c94
    s_waitcnt vmcnt(4)
L_c94:
    s_mov_b64 exec, 1
    s_waitcnt lgkmcnt(0)
    v_cmp_lt_i32 vcc, 125, v55
    v_readfirstlane_b32 s8, v55
    ds_add_rtn_u32 v55, v53, v54 offset:6556
    s_mov_b64 exec, -1
    s_mov_b32 s60, s100
    s_cmp_gt_i32 s8, 127
    buffer_load_dwordx4 v[196:199], v1, s[44:47], s60 offen offset:0 nt
    v_dot2c_f32_bf16 v84, v148, v8
    v_dot2c_f32_bf16 v84, v149, v9
    v_add_f32_dpp v83, v83, v83 quad_perm:[1,0,3,2] row_mask:0xf bank_mask:0xf
    v_dot2c_f32_bf16 v84, v150, v10
    v_dot2c_f32_bf16 v84, v151, v11
    v_add_f32_dpp v83, v83, v83 quad_perm:[2,3,0,1] row_mask:0xf bank_mask:0xf
    s_waitcnt vmcnt(11)
    s_cbranch_scc1 L_c95
    s_waitcnt vmcnt(7)
    s_cbranch_vccnz L_c95
    s_waitcnt vmcnt(4)
L_c95:
    buffer_load_dwordx4 v[200:203], v1, s[44:47], s60 offen offset:128 nt
    v_dot2c_f32_bf16 v84, v152, v12
    v_dot2c_f32_bf16 v84, v153, v13
    v_add_f32_dpp v83, v83, v83 row_half_mirror row_mask:0xf bank_mask:0xf
    v_dot2c_f32_bf16 v84, v154, v14
    v_dot2c_f32_bf16 v84, v155, v15
    v_max_f32 v41, v41, v83
    s_waitcnt vmcnt(11)
    s_cbranch_scc1 L_c96
    s_waitcnt vmcnt(7)
    s_cbranch_vccnz L_c96
    s_waitcnt vmcnt(4)
L_c96:
    buffer_load_dwordx4 v[204:207], v1, s[44:47], s60 offen offset:256 nt
    v_dot2c_f32_bf16 v84, v156, v16
    v_dot2c_f32_bf16 v84, v157, v17
    v_dot2c_f32_bf16 v84, v158, v18
    v_dot2c_f32_bf16 v84, v159, v19
    s_waitcnt vmcnt(11)
    s_cbranch_scc1 L_c97
    s_waitcnt vmcnt(7)
    s_cbranch_vccnz L_c97
    s_waitcnt vmcnt(4)
L_c97:
    s_mov_b64 exec, 1
    s_waitcnt lgkmcnt(0)
    v_cmp_lt_i32 vcc, 129, v55
    v_readfirstlane_b32 s8, v55
    ds_add_rtn_u32 v55, v53, v54 offset:6556
    s_mov_b64 exec, -1
    s_add_u32 s60, s60, 12288
    s_cmp_eq_u32 s60, 393216
    s_cselect_b32 s60, 0, s60
    s_cmp_gt_i32 s8, 131
    buffer_load_dwordx4 v[208:211], v1, s[44:47], s60 offen offset:0 nt
    v_dot2c_f32_bf16 v85, v160, v8
    v_dot2c_f32_bf16 v85, v161, v9
    v_add_f32_dpp v84, v84, v84 quad_perm:[1,0,3,2] row_mask:0xf bank_mask:0xf
    v_dot2c_f32_bf16 v85, v162, v10
    v_dot2c_f32_bf16 v85, v163, v11
    v_add_f32_dpp v84, v84, v84 quad_perm:[2,3,0,1] row_mask:0xf bank_mask:0xf
    s_waitcnt vmcnt(11)
    s_cbranch_scc1 L_c98
    s_waitcnt vmcnt(7)
    s_cbranch_vccnz L_c98
    s_waitcnt vmcnt(4)
L_c98:
    buffer_load_dwordx4 v[212:215], v1, s[44:47], s60 offen offset:128 nt
    v_dot2c_f32_bf16 v85, v164, v12
    v_dot2c_f32_bf16 v85, v165, v13
    v_add_f32_dpp v84, v84, v84 row_half_mirror row_mask:0xf bank_mask:0xf
    v_dot2c_f32_bf16 v85, v166, v14
    v_dot2c_f32_bf16 v85, v167, v15
    v_max_f32 v41, v41, v84
    s_waitcnt vmcnt(11)
    s_cbranch_scc1 L_c99
    s_waitcnt vmcnt(7)
    s_cbranch_vccnz L_c99
    s_waitcnt vmcnt(4)
L_c99:
    buffer_load_dwordx4 v[216:219], v1, s[44:47], s60 offen offset:256 nt
    v_dot2c_f32_bf16 v85, v168, v16
    v_dot2c_f32_bf16 v85, v169, v17
    v_dot2c_f32_bf16 v85, v170, v18
    v_dot2c_f32_bf16 v85, v171, v19
    s_waitcnt vmcnt(11)
    s_cbranch_scc1 L_c100
    s_waitcnt vmcnt(7)
    s_cbranch_vccnz L_c100
    s_waitcnt vmcnt(4)
L_c100:
    s_mov_b64 exec, 1
    s_waitcnt lgkmcnt(0)
    v_cmp_lt_i32 vcc, 133, v55
    v_readfirstlane_b32 s8, v55
    ds_add_rtn_u32 v55, v53, v54 offset:6556
    s_mov_b64 exec, -1
    s_add_u32 s60, s60, 12288
    s_cmp_eq_u32 s60, 393216
    s_cselect_b32 s60, 0, s60
    s_cmp_gt_i32 s8, 135
    buffer_load_dwordx4 v[220:223], v1, s[44:47], s60 offen offset:0 nt
    v_dot2c_f32_bf16 v86, v172, v8
    v_dot2c_f32_bf16 v86, v173, v9
    v_add_f32_dpp v85, v85, v85 quad_perm:[1,0,3,2] row_mask:0xf bank_mask:0xf
    v_dot2c_f32_bf16 v86, v174, v10
    v_dot2c_f32_bf16 v86, v175, v11
    v_add_f32_dpp v85, v85, v85 quad_perm:[2,3,0,1] row_mask:0xf bank_mask:0xf
    s_waitcnt vmcnt(11)
    s_cbranch_scc1 L_c101
    s_waitcnt vmcnt(7)
    s_cbranch_vccnz L_c101
    s_waitcnt vmcnt(4)
L_c101:
    buffer_load_dwordx4 v[224:227], v1, s[44:47], s60 offen offset:128 nt
    v_dot2c_f32_bf16 v86, v176, v12
    v_dot2c_f32_bf16 v86, v177, v13
    v_add_f32_dpp v85, v85, v85 row_half_mirror row_mask:0xf bank_mask:0xf
    v_dot2c_f32_bf16 v86, v178, v14
    v_dot2c_f32_bf16 v86, v179, v15
    v_max_f32 v41, v41, v85
    s_waitcnt vmcnt(11)
    s_cbranch_scc1 L_c102
    s_waitcnt vmcnt(7)
    s_cbranch_vccnz L_c102
    s_waitcnt vmcnt(4)
L_c102:
    buffer_load_dwordx4 v[228:231], v1, s[44:47], s60 offen offset:256 nt
    v_dot2c_f32_bf16 v86, v180, v16
    v_dot2c_f32_bf16 v86, v181, v17
    v_dot2c_f32_bf16 v86, v182, v18
    v_dot2c_f32_bf16 v86, v183, v19
    s_waitcnt vmcnt(11)
    s_cbranch_scc1 L_c103
    s_waitcnt vmcnt(7)
    s_cbranch_vccnz L_c103
    s_waitcnt vmcnt(4)
L_c103:
    s_mov_b64 exec, 1
    s_waitcnt lgkmcnt(0)
    v_cmp_lt_i32 vcc, 137, v55
    v_readfirstlane_b32 s8, v55
    ds_add_rtn_u32 v55, v53, v54 offset:6556
    s_mov_b64 exec, -1
    s_add_u32 s60, s60, 12288
    s_cmp_eq_u32 s60, 393216
    s_cselect_b32 s60, 0, s60
    s_cmp_gt_i32 s8, 139
    buffer_load_dwordx4 v[232:235], v1, s[44:47], s60 offen offset:0 nt
    v_dot2c_f32_bf16 v87, v184, v8
    v_dot2c_f32_bf16 v87, v185, v9
    v_add_f32_dpp v86, v86, v86 quad_perm:[1,0,3,2] row_mask:0xf bank_mask:0xf
    v_dot2c_f32_bf16 v87, v186, v10
    v_dot2c_f32_bf16 v87, v187, v11
    v_add_f32_dpp v86, v86, v86 quad_perm:[2,3,0,1] row_mask:0xf bank_mask:0xf
    s_waitcnt vmcnt(11)
    s_cbranch_scc1 L_c104
    s_waitcnt vmcnt(7)
    s_cbranch_vccnz L_c104
    s_waitcnt vmcnt(4)
L_c104:
    buffer_load_dwordx4 v[236:239], v1, s[44:47], s60 offen offset:128 nt
    v_dot2c_f32_bf16 v87, v188, v12
    v_dot2c_f32_bf16 v87, v189, v13
    v_add_f32_dpp v86, v86, v86 row_half_mirror row_mask:0xf bank_mask:0xf
    v_dot2c_f32_bf16 v87, v190, v14
    v_dot2c_f32_bf16 v87, v191, v15
    v_max_f32 v41, v41, v86
    s_waitcnt vmcnt(11)
    s_cbranch_scc1 L_c105
    s_waitcnt vmcnt(7)
    s_cbranch_vccnz L_c105
    s_waitcnt vmcnt(4)
L_c105:
    buffer_load_dwordx4 v[240:243], v1, s[44:47], s60 offen offset:256 nt
    v_dot2c_f32_bf16 v87, v192, v16
    v_dot2c_f32_bf16 v87, v193, v17
    v_dot2c_f32_bf16 v87, v194, v18
    v_dot2c_f32_bf16 v87, v195, v19
    s_nop 2
    v_add_f32_dpp v87, v87, v87 quad_perm:[1,0,3,2] row_mask:0xf bank_mask:0xf
    s_nop 1
    v_add_f32_dpp v87, v87, v87 quad_perm:[2,3,0,1] row_mask:0xf bank_mask:0xf
    s_nop 1
    v_add_f32_dpp v87, v87, v87 row_half_mirror row_mask:0xf bank_mask:0xf
    v_max_f32 v41, v41, v87
    s_nop 1
    v_max_f32_dpp v41, v41, v41 row_ror:8 row_mask:0xf bank_mask:0xf
    v_mov_b32 v49, v41
    s_nop 1
    v_permlane16_swap_b32 v41, v49
    v_max_f32 v41, v41, v49
    v_mov_b32 v49, v41
    s_nop 1
    v_permlane32_swap_b32 v41, v49
    v_max_f32 v41, v41, v49
    v_mul_f32 v41, s61, v41
    v_sub_f32 v43, 0, v41
    v_fma_f32 v56, v56, s61, v43
    v_exp_f32 v56, v56
    s_nop 0
    v_mov_b32 v42, v56
    v_cvt_pk_bf16_f32 v56, v56, v56
    v_fma_f32 v57, v57, s61, v43
    v_exp_f32 v57, v57
    s_nop 0
    v_add_f32 v42, v42, v57
    v_cvt_pk_bf16_f32 v57, v57, v57
    s_waitcnt vmcnt(11)
    s_cbranch_scc1 L_c106
    s_waitcnt vmcnt(7)
    s_cbranch_vccnz L_c106
    s_waitcnt vmcnt(4)
L_c106:
    s_mov_b64 exec, 1
    s_waitcnt lgkmcnt(0)
    v_cmp_lt_i32 vcc, 141, v55
    v_readfirstlane_b32 s8, v55
    ds_add_rtn_u32 v55, v53, v54 offset:6556
    s_mov_b64 exec, -1
    s_add_u32 s60, s60, 12288
    s_cmp_eq_u32 s60, 393216
    s_cselect_b32 s60, 0, s60
    s_cmp_gt_i32 s8, 143
    buffer_load_dwordx4 v[244:247], v1, s[44:47], s60 offen offset:0 nt
    v_and_b32 v32, v56, v4
    v_and_b32 v33, v56, v5
    v_and_b32 v34, v56, v6
    v_and_b32 v35, v56, v7
    s_nop 1
    v_mfma_f32_16x16x32_bf16 v[20:23], v[32:35], v[196:199], 0
    v_fma_f32 v58, v58, s61, v43
    v_exp_f32 v58, v58
    s_nop 0
    v_add_f32 v42, v42, v58
    v_cvt_pk_bf16_f32 v58, v58, v58
    s_waitcnt vmcnt(11)
    s_cbranch_scc1 L_c107
    s_waitcnt vmcnt(7)
    s_cbranch_vccnz L_c107
    s_waitcnt vmcnt(4)
L_c107:
    buffer_load_dwordx4 v[248:251], v1, s[44:47], s60 offen offset:128 nt
    v_mfma_f32_16x16x32_bf16 v[24:27], v[32:35], v[200:203], 0
    v_fma_f32 v59, v59, s61, v43
    v_exp_f32 v59, v59
    s_nop 0
    v_add_f32 v42, v42, v59
    v_cvt_pk_bf16_f32 v59, v59, v59
    s_waitcnt vmcnt(11)
    s_cbranch_scc1 L_c108
    s_waitcnt vmcnt(7)
    s_cbranch_vccnz L_c108
    s_waitcnt vmcnt(4)
L_c108:
    buffer_load_dwordx4 v[252:255], v1, s[44:47], s60 offen offset:256 nt
    v_mfma_f32_16x16x32_bf16 v[28:31], v[32:35], v[204:207], 0
    s_waitcnt vmcnt(11)
    s_cbranch_scc1 L_c109
    s_waitcnt vmcnt(7)
    s_cbranch_vccnz L_c109
    s_waitcnt vmcnt(4)
L_c109:
    s_mov_b64 exec, 1
    s_waitcnt lgkmcnt(0)
    v_cmp_lt_i32 vcc, 145, v55
    v_readfirstlane_b32 s8, v55
    ds_add_rtn_u32 v55, v53, v54 offset:6556
    s_mov_b64 exec, -1
    s_add_u32 s60, s60, 12288
    s_cmp_eq_u32 s60, 393216
    s_cselect_b32 s60, 0, s60
    s_cmp_gt_i32 s8, 147
    buffer_load_dwordx4 v[88:91], v1, s[44:47], s60 offen offset:0 nt
    v_and_b32 v32, v57, v4
    v_and_b32 v33, v57, v5
    v_and_b32 v34, v57, v6
    v_and_b32 v35, v57, v7
    s_nop 1
    v_mfma_f32_16x16x32_bf16 v[20:23], v[32:35], v[208:211], v[20:23]
    v_fma_f32 v60, v60, s61, v43
    v_exp_f32 v60, v60
    s_nop 0
    v_add_f32 v42, v42, v60
    v_cvt_pk_bf16_f32 v60, v60, v60
    s_waitcnt vmcnt(11)
    s_cbranch_scc1 L_c110
    s_waitcnt vmcnt(7)
    s_cbranch_vccnz L_c110
    s_waitcnt vmcnt(4)
L_c110:
    buffer_load_dwordx4 v[92:95], v1, s[44:47], s60 offen offset:128 nt
    v_mfma_f32_16x16x32_bf16 v[24:27], v[32:35], v[212:215], v[24:27]
    v_fma_f32 v61, v61, s61, v43
    v_exp_f32 v61, v61
    s_nop 0
    v_add_f32 v42, v42, v61
    v_cvt_pk_bf16_f32 v61, v61, v61
    s_waitcnt vmcnt(11)
    s_cbranch_scc1 L_c111
    s_waitcnt vmcnt(7)
    s_cbranch_vccnz L_c111
    s_waitcnt vmcnt(4)
L_c111:
    buffer_load_dwordx4 v[96:99], v1, s[44:47], s60 offen offset:256 nt
    v_mfma_f32_16x16x32_bf16 v[28:31], v[32:35], v[216:219], v[28:31]
    s_waitcnt vmcnt(11)
    s_cbranch_scc1 L_c112
    s_waitcnt vmcnt(7)
    s_cbranch_vccnz L_c112
    s_waitcnt vmcnt(4)
L_c112:
    s_mov_b64 exec, 1
    s_waitcnt lgkmcnt(0)
    v_cmp_lt_i32 vcc, 149, v55
    v_readfirstlane_b32 s8, v55
    ds_add_rtn_u32 v55, v53, v54 offset:6556
    s_mov_b64 exec, -1
    s_add_u32 s60, s60, 12288
    s_cmp_eq_u32 s60, 393216
    s_cselect_b32 s60, 0, s60
    s_cmp_gt_i32 s8, 151
    buffer_load_dwordx4 v[100:103], v1, s[44:47], s60 offen offset:0 nt
    v_and_b32 v32, v58, v4
    v_and_b32 v33, v58, v5
    v_and_b32 v34, v58, v6
    v_and_b32 v35, v58, v7
    s_nop 1
    v_mfma_f32_16x16x32_bf16 v[20:23], v[32:35], v[220:223], v[20:23]
    v_fma_f32 v62, v62, s61, v43
    v_exp_f32 v62, v62
    s_nop 0
    v_add_f32 v42, v42, v62
    v_cvt_pk_bf16_f32 v62, v62, v62
    s_waitcnt vmcnt(11)
    s_cbranch_scc1 L_c113
    s_waitcnt vmcnt(7)
    s_cbranch_vccnz L_c113
    s_waitcnt vmcnt(4)
L_c113:
    buffer_load_dwordx4 v[104:107], v1, s[44:47], s60 offen offset:128 nt
    v_mfma_f32_16x16x32_bf16 v[24:27], v[32:35], v[224:227], v[24:27]
    v_fma_f32 v63, v63, s61, v43
    v_exp_f32 v63, v63
    s_nop 0
    v_add_f32 v42, v42, v63
    v_cvt_pk_bf16_f32 v63, v63, v63
    s_waitcnt vmcnt(11)
    s_cbranch_scc1 L_c114
    s_waitcnt vmcnt(7)
    s_cbranch_vccnz L_c114
    s_waitcnt vmcnt(4)
L_c114:
    buffer_load_dwordx4 v[108:111], v1, s[44:47], s60 offen offset:256 nt
    v_mfma_f32_16x16x32_bf16 v[28:31], v[32:35], v[228:231], v[28:31]
    s_waitcnt vmcnt(11)
    s_cbranch_scc1 L_c115
    s_waitcnt vmcnt(7)
    s_cbranch_vccnz L_c115
    s_waitcnt vmcnt(4)
L_c115:
    s_mov_b64 exec, 1
    s_waitcnt lgkmcnt(0)
    v_cmp_lt_i32 vcc, 153, v55
    v_readfirstlane_b32 s8, v55
    ds_add_rtn_u32 v55, v53, v54 offset:6556
    s_mov_b64 exec, -1
    s_add_u32 s60, s60, 12288
    s_cmp_eq_u32 s60, 393216
    s_cselect_b32 s60, 0, s60
    s_cmp_gt_i32 s8, 155
    buffer_load_dwordx4 v[112:115], v1, s[44:47], s60 offen offset:0 nt
    v_and_b32 v32, v59, v4
    v_and_b32 v33, v59, v5
    v_and_b32 v34, v59, v6
    v_and_b32 v35, v59, v7
    s_nop 1
    v_mfma_f32_16x16x32_bf16 v[20:23], v[32:35], v[232:235], v[20:23]
    v_fma_f32 v64, v64, s61, v43
    v_exp_f32 v64, v64
    s_nop 0
    v_add_f32 v42, v42, v64
    v_cvt_pk_bf16_f32 v64, v64, v64
    s_waitcnt vmcnt(11)
    s_cbranch_scc1 L_c116
    s_waitcnt vmcnt(7)
    s_cbranch_vccnz L_c116
    s_waitcnt vmcnt(4)
L_c116:
    buffer_load_dwordx4 v[116:119], v1, s[44:47], s60 offen offset:128 nt
    v_mfma_f32_16x16x32_bf16 v[24:27], v[32:35], v[236:239], v[24:27]
    v_fma_f32 v65, v65, s61, v43
    v_exp_f32 v65, v65
    s_nop 0
    v_add_f32 v42, v42, v65
    v_cvt_pk_bf16_f32 v65, v65, v65
    s_waitcnt vmcnt(11)
    s_cbranch_scc1 L_c117
    s_waitcnt vmcnt(7)
    s_cbranch_vccnz L_c117
    s_waitcnt vmcnt(4)
L_c117:
    buffer_load_dwordx4 v[120:123], v1, s[44:47], s60 offen offset:256 nt
    v_mfma_f32_16x16x32_bf16 v[28:31], v[32:35], v[240:243], v[28:31]
    s_waitcnt vmcnt(11)
    s_cbranch_scc1 L_c118
    s_waitcnt vmcnt(7)
    s_cbranch_vccnz L_c118
    s_waitcnt vmcnt(4)
L_c118:
    s_mov_b64 exec, 1
    s_waitcnt lgkmcnt(0)
    v_cmp_lt_i32 vcc, 157, v55
    v_readfirstlane_b32 s8, v55
    ds_add_rtn_u32 v55, v53, v54 offset:6556
    s_mov_b64 exec, -1
    s_add_u32 s60, s60, 12288
    s_cmp_eq_u32 s60, 393216
    s_cselect_b32 s60, 0, s60
    s_cmp_gt_i32 s8, 159
    buffer_load_dwordx4 v[124:127], v1, s[44:47], s60 offen offset:0 nt
    v_and_b32 v32, v60, v4
    v_and_b32 v33, v60, v5
    v_and_b32 v34, v60, v6
    v_and_b32 v35, v60, v7
    s_nop 1
    v_mfma_f32_16x16x32_bf16 v[20:23], v[32:35], v[244:247], v[20:23]
    v_fma_f32 v66, v66, s61, v43
    v_exp_f32 v66, v66
    s_nop 0
    v_add_f32 v42, v42, v66
    v_cvt_pk_bf16_f32 v66, v66, v66
    s_waitcnt vmcnt(11)
    s_cbranch_scc1 L_c119
    s_waitcnt vmcnt(7)
    s_cbranch_vccnz L_c119
    s_waitcnt vmcnt(4)
L_c119:
    buffer_load_dwordx4 v[128:131], v1, s[44:47], s60 offen offset:128 nt
    v_mfma_f32_16x16x32_bf16 v[24:27], v[32:35], v[248:251], v[24:27]
    v_fma_f32 v67, v67, s61, v43
    v_exp_f32 v67, v67
    s_nop 0
    v_add_f32 v42, v42, v67
    v_cvt_pk_bf16_f32 v67, v67, v67
    s_waitcnt vmcnt(11)
    s_cbranch_scc1 L_c120
    s_waitcnt vmcnt(7)
    s_cbranch_vccnz L_c120
    s_waitcnt vmcnt(4)
L_c120:
    buffer_load_dwordx4 v[132:135], v1, s[44:47], s60 offen offset:256 nt
    v_mfma_f32_16x16x32_bf16 v[28:31], v[32:35], v[252:255], v[28:31]
    s_waitcnt vmcnt(11)
    s_cbranch_scc1 L_c121
    s_waitcnt vmcnt(7)
    s_cbranch_vccnz L_c121
    s_waitcnt vmcnt(4)
L_c121:
    s_mov_b64 exec, 1
    s_waitcnt lgkmcnt(0)
    v_cmp_lt_i32 vcc, 161, v55
    v_readfirstlane_b32 s8, v55
    ds_add_rtn_u32 v55, v53, v54 offset:6556
    s_mov_b64 exec, -1
    s_add_u32 s60, s60, 12288
    s_cmp_eq_u32 s60, 393216
    s_cselect_b32 s60, 0, s60
    s_cmp_gt_i32 s8, 163
    buffer_load_dwordx4 v[136:139], v1, s[44:47], s60 offen offset:0 nt
    v_and_b32 v32, v61, v4
    v_and_b32 v33, v61, v5
    v_and_b32 v34, v61, v6
    v_and_b32 v35, v61, v7
    s_nop 1
    v_mfma_f32_16x16x32_bf16 v[20:23], v[32:35], v[88:91], v[20:23]
    v_fma_f32 v68, v68, s61, v43
    v_exp_f32 v68, v68
    s_nop 0
    v_add_f32 v42, v42, v68
    v_cvt_pk_bf16_f32 v68, v68, v68
    s_waitcnt vmcnt(11)
    s_cbranch_scc1 L_c122
    s_waitcnt vmcnt(7)
    s_cbranch_vccnz L_c122
    s_waitcnt vmcnt(4)
L_c122:
    buffer_load_dwordx4 v[140:143], v1, s[44:47], s60 offen offset:128 nt
    v_mfma_f32_16x16x32_bf16 v[24:27], v[32:35], v[92:95], v[24:27]
    v_fma_f32 v69, v69, s61, v43
    v_exp_f32 v69, v69
    s_nop 0
    v_add_f32 v42, v42, v69
    v_cvt_pk_bf16_f32 v69, v69, v69
    s_waitcnt vmcnt(11)
    s_cbranch_scc1 L_c123
    s_waitcnt vmcnt(7)
    s_cbranch_vccnz L_c123
    s_waitcnt vmcnt(4)
L_c123:
    buffer_load_dwordx4 v[144:147], v1, s[44:47], s60 offen offset:256 nt
    v_mfma_f32_16x16x32_bf16 v[28:31], v[32:35], v[96:99], v[28:31]
    s_waitcnt vmcnt(11)
    s_cbranch_scc1 L_c124
    s_waitcnt vmcnt(7)
    s_cbranch_vccnz L_c124
    s_waitcnt vmcnt(4)
L_c124:
    s_mov_b64 exec, 1
    s_waitcnt lgkmcnt(0)
    v_cmp_lt_i32 vcc, 165, v55
    v_readfirstlane_b32 s8, v55
    ds_add_rtn_u32 v55, v53, v54 offset:6556
    s_mov_b64 exec, -1
    s_add_u32 s60, s60, 12288
    s_cmp_eq_u32 s60, 393216
    s_cselect_b32 s60, 0, s60
    s_cmp_gt_i32 s8, 167
    buffer_load_dwordx4 v[148:151], v1, s[44:47], s60 offen offset:0 nt
    v_and_b32 v32, v62, v4
    v_and_b32 v33, v62, v5
    v_and_b32 v34, v62, v6
    v_and_b32 v35, v62, v7
    s_nop 1
    v_mfma_f32_16x16x32_bf16 v[20:23], v[32:35], v[100:103], v[20:23]
    v_fma_f32 v70, v70, s61, v43
    v_exp_f32 v70, v70
    s_nop 0
    v_add_f32 v42, v42, v70
    v_cvt_pk_bf16_f32 v70, v70, v70
    s_waitcnt vmcnt(11)
    s_cbranch_scc1 L_c125
    s_waitcnt vmcnt(7)
    s_cbranch_vccnz L_c125
    s_waitcnt vmcnt(4)
L_c125:
    buffer_load_dwordx4 v[152:155], v1, s[44:47], s60 offen offset:128 nt
    v_mfma_f32_16x16x32_bf16 v[24:27], v[32:35], v[104:107], v[24:27]
    v_fma_f32 v71, v71, s61, v43
    v_exp_f32 v71, v71
    s_nop 0
    v_add_f32 v42, v42, v71
    v_cvt_pk_bf16_f32 v71, v71, v71
    s_waitcnt vmcnt(11)
    s_cbranch_scc1 L_c126
    s_waitcnt vmcnt(7)
    s_cbranch_vccnz L_c126
    s_waitcnt vmcnt(4)
L_c126:
    buffer_load_dwordx4 v[156:159], v1, s[44:47], s60 offen offset:256 nt
    v_mfma_f32_16x16x32_bf16 v[28:31], v[32:35], v[108:111], v[28:31]
    s_waitcnt vmcnt(11)
    s_cbranch_scc1 L_c127
    s_waitcnt vmcnt(7)
    s_cbranch_vccnz L_c127
    s_waitcnt vmcnt(4)
L_c127:
    s_mov_b64 exec, 1
    s_waitcnt lgkmcnt(0)
    v_cmp_lt_i32 vcc, 169, v55
    v_readfirstlane_b32 s8, v55
    ds_add_rtn_u32 v55, v53, v54 offset:6556
    s_mov_b64 exec, -1
    s_add_u32 s60, s60, 12288
    s_cmp_eq_u32 s60, 393216
    s_cselect_b32 s60, 0, s60
    s_cmp_gt_i32 s8, 171
    buffer_load_dwordx4 v[160:163], v1, s[44:47], s60 offen offset:0 nt
    v_and_b32 v32, v63, v4
    v_and_b32 v33, v63, v5
    v_and_b32 v34, v63, v6
    v_and_b32 v35, v63, v7
    s_nop 1
    v_mfma_f32_16x16x32_bf16 v[20:23], v[32:35], v[112:115], v[20:23]
    v_fma_f32 v72, v72, s61, v43
    v_exp_f32 v72, v72
    s_nop 0
    v_add_f32 v42, v42, v72
    v_cvt_pk_bf16_f32 v72, v72, v72
    s_waitcnt vmcnt(11)
    s_cbranch_scc1 L_c128
    s_waitcnt vmcnt(7)
    s_cbranch_vccnz L_c128
    s_waitcnt vmcnt(4)
L_c128:
    buffer_load_dwordx4 v[164:167], v1, s[44:47], s60 offen offset:128 nt
    v_mfma_f32_16x16x32_bf16 v[24:27], v[32:35], v[116:119], v[24:27]
    v_fma_f32 v73, v73, s61, v43
    v_exp_f32 v73, v73
    s_nop 0
    v_add_f32 v42, v42, v73
    v_cvt_pk_bf16_f32 v73, v73, v73
    s_waitcnt vmcnt(11)
    s_cbranch_scc1 L_c129
    s_waitcnt vmcnt(7)
    s_cbranch_vccnz L_c129
    s_waitcnt vmcnt(4)
L_c129:
    buffer_load_dwordx4 v[168:171], v1, s[44:47], s60 offen offset:256 nt
    v_mfma_f32_16x16x32_bf16 v[28:31], v[32:35], v[120:123], v[28:31]
    s_waitcnt vmcnt(11)
    s_cbranch_scc1 L_c130
    s_waitcnt vmcnt(7)
    s_cbranch_vccnz L_c130
    s_waitcnt vmcnt(4)
L_c130:
    s_mov_b64 exec, 1
    s_waitcnt lgkmcnt(0)
    v_cmp_lt_i32 vcc, 173, v55
    v_readfirstlane_b32 s8, v55
    ds_add_rtn_u32 v55, v53, v54 offset:6556
    s_mov_b64 exec, -1
    s_add_u32 s60, s60, 12288
    s_cmp_eq_u32 s60, 393216
    s_cselect_b32 s60, 0, s60
    s_cmp_gt_i32 s8, 175
    buffer_load_dwordx4 v[172:175], v1, s[44:47], s60 offen offset:0 nt
    v_and_b32 v32, v64, v4
    v_and_b32 v33, v64, v5
    v_and_b32 v34, v64, v6
    v_and_b32 v35, v64, v7
    s_nop 1
    v_mfma_f32_16x16x32_bf16 v[20:23], v[32:35], v[124:127], v[20:23]
    v_fma_f32 v74, v74, s61, v43
    v_exp_f32 v74, v74
    s_nop 0
    v_add_f32 v42, v42, v74
    v_cvt_pk_bf16_f32 v74, v74, v74
    s_waitcnt vmcnt(11)
    s_cbranch_scc1 L_c131
    s_waitcnt vmcnt(7)
    s_cbranch_vccnz L_c131
    s_waitcnt vmcnt(4)
L_c131:
    buffer_load_dwordx4 v[176:179], v1, s[44:47], s60 offen offset:128 nt
    v_mfma_f32_16x16x32_bf16 v[24:27], v[32:35], v[128:131], v[24:27]
    v_fma_f32 v75, v75, s61, v43
    v_exp_f32 v75, v75
    s_nop 0
    v_add_f32 v42, v42, v75
    v_cvt_pk_bf16_f32 v75, v75, v75
    s_waitcnt vmcnt(11)
    s_cbranch_scc1 L_c132
    s_waitcnt vmcnt(7)
    s_cbranch_vccnz L_c132
    s_waitcnt vmcnt(4)
L_c132:
    buffer_load_dwordx4 v[180:183], v1, s[44:47], s60 offen offset:256 nt
    v_mfma_f32_16x16x32_bf16 v[28:31], v[32:35], v[132:135], v[28:31]
    s_waitcnt vmcnt(11)
    s_cbranch_scc1 L_c133
    s_waitcnt vmcnt(7)
    s_cbranch_vccnz L_c133
    s_waitcnt vmcnt(4)
L_c133:
    s_mov_b64 exec, 1
    s_waitcnt lgkmcnt(0)
    v_cmp_lt_i32 vcc, 177, v55
    v_readfirstlane_b32 s8, v55
    ds_add_rtn_u32 v55, v53, v54 offset:6556
    s_mov_b64 exec, -1
    s_add_u32 s60, s60, 12288
    s_cmp_eq_u32 s60, 393216
    s_cselect_b32 s60, 0, s60
    s_cmp_gt_i32 s8, 179
    buffer_load_dwordx4 v[184:187], v1, s[44:47], s60 offen offset:0 nt
    v_and_b32 v32, v65, v4
    v_and_b32 v33, v65, v5
    v_and_b32 v34, v65, v6
    v_and_b32 v35, v65, v7
    s_nop 1
    v_mfma_f32_16x16x32_bf16 v[20:23], v[32:35], v[136:139], v[20:23]
    v_fma_f32 v76, v76, s61, v43
    v_exp_f32 v76, v76
    s_nop 0
    v_add_f32 v42, v42, v76
    v_cvt_pk_bf16_f32 v76, v76, v76
    s_waitcnt vmcnt(11)
    s_cbranch_scc1 L_c134
    s_waitcnt vmcnt(7)
    s_cbranch_vccnz L_c134
    s_waitcnt vmcnt(4)
L_c134:
    buffer_load_dwordx4 v[188:191], v1, s[44:47], s60 offen offset:128 nt
    v_mfma_f32_16x16x32_bf16 v[24:27], v[32:35], v[140:143], v[24:27]
    v_fma_f32 v77, v77, s61, v43
    v_exp_f32 v77, v77
    s_nop 0
    v_add_f32 v42, v42, v77
    v_cvt_pk_bf16_f32 v77, v77, v77
    s_waitcnt vmcnt(11)
    s_cbranch_scc1 L_c135
    s_waitcnt vmcnt(7)
    s_cbranch_vccnz L_c135
    s_waitcnt vmcnt(4)
L_c135:
    buffer_load_dwordx4 v[192:195], v1, s[44:47], s60 offen offset:256 nt
    v_mfma_f32_16x16x32_bf16 v[28:31], v[32:35], v[144:147], v[28:31]
    s_waitcnt vmcnt(11)
    s_cbranch_scc1 L_c136
    s_waitcnt vmcnt(7)
    s_cbranch_vccnz L_c136
    s_waitcnt vmcnt(4)
L_c136:
    s_mov_b64 exec, 1
    s_waitcnt lgkmcnt(0)
    v_cmp_lt_i32 vcc, 181, v55
    v_readfirstlane_b32 s8, v55
    ds_add_rtn_u32 v55, v53, v54 offset:6556
    s_mov_b64 exec, -1
    s_add_u32 s60, s60, 12288
    s_cmp_eq_u32 s60, 393216
    s_cselect_b32 s60, 0, s60
    s_cmp_gt_i32 s8, 183
    buffer_load_dwordx4 v[196:199], v1, s[44:47], s60 offen offset:0 nt
    v_and_b32 v32, v66, v4
    v_and_b32 v33, v66, v5
    v_and_b32 v34, v66, v6
    v_and_b32 v35, v66, v7
    s_nop 1
    v_mfma_f32_16x16x32_bf16 v[20:23], v[32:35], v[148:151], v[20:23]
    v_fma_f32 v78, v78, s61, v43
    v_exp_f32 v78, v78
    s_nop 0
    v_add_f32 v42, v42, v78
    v_cvt_pk_bf16_f32 v78, v78, v78
    s_waitcnt vmcnt(11)
    s_cbranch_scc1 L_c137
    s_waitcnt vmcnt(7)
    s_cbranch_vccnz L_c137
    s_waitcnt vmcnt(4)
L_c137:
    buffer_load_dwordx4 v[200:203], v1, s[44:47], s60 offen offset:128 nt
    v_mfma_f32_16x16x32_bf16 v[24:27], v[32:35], v[152:155], v[24:27]
    v_fma_f32 v79, v79, s61, v43
    v_exp_f32 v79, v79
    s_nop 0
    v_add_f32 v42, v42, v79
    v_cvt_pk_bf16_f32 v79, v79, v79
    s_waitcnt vmcnt(11)
    s_cbranch_scc1 L_c138
    s_waitcnt vmcnt(7)
    s_cbranch_vccnz L_c138
    s_waitcnt vmcnt(4)
L_c138:
    buffer_load_dwordx4 v[204:207], v1, s[44:47], s60 offen offset:256 nt
    v_mfma_f32_16x16x32_bf16 v[28:31], v[32:35], v[156:159], v[28:31]
    s_waitcnt vmcnt(11)
    s_cbranch_scc1 L_c139
    s_waitcnt vmcnt(7)
    s_cbranch_vccnz L_c139
    s_waitcnt vmcnt(4)
L_c139:
    s_mov_b64 exec, 1
    s_waitcnt lgkmcnt(0)
    v_cmp_lt_i32 vcc, 185, v55
    v_readfirstlane_b32 s8, v55
    ds_add_rtn_u32 v55, v53, v54 offset:6556
    s_mov_b64 exec, -1
    s_add_u32 s60, s60, 12288
    s_cmp_eq_u32 s60, 393216
    s_cselect_b32 s60, 0, s60
    s_cmp_gt_i32 s8, 187
    buffer_load_dwordx4 v[208:211], v1, s[44:47], s60 offen offset:0 nt
    v_and_b32 v32, v67, v4
    v_and_b32 v33, v67, v5
    v_and_b32 v34, v67, v6
    v_and_b32 v35, v67, v7
    s_nop 1
    v_mfma_f32_16x16x32_bf16 v[20:23], v[32:35], v[160:163], v[20:23]
    v_fma_f32 v80, v80, s61, v43
    v_exp_f32 v80, v80
    s_nop 0
    v_add_f32 v42, v42, v80
    v_cvt_pk_bf16_f32 v80, v80, v80
    s_waitcnt vmcnt(11)
    s_cbranch_scc1 L_c140
    s_waitcnt vmcnt(7)
    s_cbranch_vccnz L_c140
    s_waitcnt vmcnt(4)
L_c140:
    buffer_load_dwordx4 v[212:215], v1, s[44:47], s60 offen offset:128 nt
    v_mfma_f32_16x16x32_bf16 v[24:27], v[32:35], v[164:167], v[24:27]
    v_fma_f32 v81, v81, s61, v43
    v_exp_f32 v81, v81
    s_nop 0
    v_add_f32 v42, v42, v81
    v_cvt_pk_bf16_f32 v81, v81, v81
    s_waitcnt vmcnt(11)
    s_cbranch_scc1 L_c141
    s_waitcnt vmcnt(7)
    s_cbranch_vccnz L_c141
    s_waitcnt vmcnt(4)
L_c141:
    buffer_load_dwordx4 v[216:219], v1, s[44:47], s60 offen offset:256 nt
    v_mfma_f32_16x16x32_bf16 v[28:31], v[32:35], v[168:171], v[28:31]
    s_waitcnt vmcnt(11)
    s_cbranch_scc1 L_c142
    s_waitcnt vmcnt(7)
    s_cbranch_vccnz L_c142
    s_waitcnt vmcnt(4)
L_c142:
    s_mov_b64 exec, 1
    s_waitcnt lgkmcnt(0)
    v_cmp_lt_i32 vcc, 189, v55
    v_readfirstlane_b32 s8, v55
    ds_add_rtn_u32 v55, v53, v54 offset:6556
    s_mov_b64 exec, -1
    s_add_u32 s60, s60, 12288
    s_cmp_eq_u32 s60, 393216
    s_cselect_b32 s60, 0, s60
    s_cmp_gt_i32 s8, 191
    buffer_load_dwordx4 v[220:223], v1, s[44:47], s60 offen offset:0 nt
    v_and_b32 v32, v68, v4
    v_and_b32 v33, v68, v5
    v_and_b32 v34, v68, v6
    v_and_b32 v35, v68, v7
    s_nop 1
    v_mfma_f32_16x16x32_bf16 v[20:23], v[32:35], v[172:175], v[20:23]
    v_fma_f32 v82, v82, s61, v43
    v_exp_f32 v82, v82
    s_nop 0
    v_add_f32 v42, v42, v82
    v_cvt_pk_bf16_f32 v82, v82, v82
    s_waitcnt vmcnt(11)
    s_cbranch_scc1 L_c143
    s_waitcnt vmcnt(7)
    s_cbranch_vccnz L_c143
    s_waitcnt vmcnt(4)
L_c143:
    buffer_load_dwordx4 v[224:227], v1, s[44:47], s60 offen offset:128 nt
    v_mfma_f32_16x16x32_bf16 v[24:27], v[32:35], v[176:179], v[24:27]
    v_fma_f32 v83, v83, s61, v43
    v_exp_f32 v83, v83
    s_nop 0
    v_add_f32 v42, v42, v83
    v_cvt_pk_bf16_f32 v83, v83, v83
    s_waitcnt vmcnt(11)
    s_cbranch_scc1 L_c144
    s_waitcnt vmcnt(7)
    s_cbranch_vccnz L_c144
    s_waitcnt vmcnt(4)
L_c144:
    buffer_load_dwordx4 v[228:231], v1, s[44:47], s60 offen offset:256 nt
    v_mfma_f32_16x16x32_bf16 v[28:31], v[32:35], v[180:183], v[28:31]
    s_waitcnt vmcnt(11)
    s_cbranch_scc1 L_c145
    s_waitcnt vmcnt(7)
    s_cbranch_vccnz L_c145
    s_waitcnt vmcnt(4)
L_c145:
    s_mov_b64 exec, 1
    s_waitcnt lgkmcnt(0)
    v_cmp_lt_i32 vcc, 193, v55
    v_readfirstlane_b32 s8, v55
    ds_add_rtn_u32 v55, v53, v54 offset:6556
    s_mov_b64 exec, -1
    s_add_u32 s60, s60, 12288
    s_cmp_eq_u32 s60, 393216
    s_cselect_b32 s60, 0, s60
    s_cmp_gt_i32 s8, 195
    buffer_load_dwordx4 v[232:235], v1, s[44:47], s60 offen offset:0 nt
    v_and_b32 v32, v69, v4
    v_and_b32 v33, v69, v5
    v_and_b32 v34, v69, v6
    v_and_b32 v35, v69, v7
    s_nop 1
    v_mfma_f32_16x16x32_bf16 v[20:23], v[32:35], v[184:187], v[20:23]
    v_fma_f32 v84, v84, s61, v43
    v_exp_f32 v84, v84
    s_nop 0
    v_add_f32 v42, v42, v84
    v_cvt_pk_bf16_f32 v84, v84, v84
    s_waitcnt vmcnt(11)
    s_cbranch_scc1 L_c146
    s_waitcnt vmcnt(7)
    s_cbranch_vccnz L_c146
    s_waitcnt vmcnt(4)
L_c146:
    buffer_load_dwordx4 v[236:239], v1, s[44:47], s60 offen offset:128 nt
    v_mfma_f32_16x16x32_bf16 v[24:27], v[32:35], v[188:191], v[24:27]
    v_fma_f32 v85, v85, s61, v43
    v_exp_f32 v85, v85
    s_nop 0
    v_add_f32 v42, v42, v85
    v_cvt_pk_bf16_f32 v85, v85, v85
    s_waitcnt vmcnt(11)
    s_cbranch_scc1 L_c147
    s_waitcnt vmcnt(7)
    s_cbranch_vccnz L_c147
    s_waitcnt vmcnt(4)
L_c147:
    buffer_load_dwordx4 v[240:243], v1, s[44:47], s60 offen offset:256 nt
    v_mfma_f32_16x16x32_bf16 v[28:31], v[32:35], v[192:195], v[28:31]
    s_waitcnt vmcnt(11)
    s_cbranch_scc1 L_c148
    s_waitcnt vmcnt(7)
    s_cbranch_vccnz L_c148
    s_waitcnt vmcnt(4)
L_c148:
    s_mov_b64 exec, 1
    s_waitcnt lgkmcnt(0)
    v_cmp_lt_i32 vcc, 197, v55
    v_readfirstlane_b32 s8, v55
    ds_add_rtn_u32 v55, v53, v54 offset:6556
    s_mov_b64 exec, -1
    s_add_u32 s60, s60, 12288
    s_cmp_eq_u32 s60, 393216
    s_cselect_b32 s60, 0, s60
    s_cmp_gt_i32 s8, 199
    buffer_load_dwordx4 v[244:247], v1, s[44:47], s60 offen offset:0 nt
    v_and_b32 v32, v70, v4
    v_and_b32 v33, v70, v5
    v_and_b32 v34, v70, v6
    v_and_b32 v35, v70, v7
    s_nop 1
    v_mfma_f32_16x16x32_bf16 v[20:23], v[32:35], v[196:199], v[20:23]
    v_fma_f32 v86, v86, s61, v43
    v_exp_f32 v86, v86
    s_nop 0
    v_add_f32 v42, v42, v86
    v_cvt_pk_bf16_f32 v86, v86, v86
    s_waitcnt vmcnt(11)
    s_cbranch_scc1 L_c149
    s_waitcnt vmcnt(7)
    s_cbranch_vccnz L_c149
    s_waitcnt vmcnt(4)
L_c149:
    buffer_load_dwordx4 v[248:251], v1, s[44:47], s60 offen offset:128 nt
    v_mfma_f32_16x16x32_bf16 v[24:27], v[32:35], v[200:203], v[24:27]
    v_fma_f32 v87, v87, s61, v43
    v_exp_f32 v87, v87
    s_nop 0
    v_add_f32 v42, v42, v87
    v_cvt_pk_bf16_f32 v87, v87, v87
    s_nop 0
    v_add_f32_dpp v42, v42, v42 row_ror:8 row_mask:0xf bank_mask:0xf
    v_mov_b32 v49, v42
    s_nop 1
    v_permlane16_swap_b32 v42, v49
    v_add_f32 v42, v42, v49
    v_mov_b32 v49, v42
    s_nop 1
    v_permlane32_swap_b32 v42, v49
    v_add_f32 v42, v42, v49
    s_lshl_b32 s3, s14, 3
    v_mov_b32 v49, s3
    s_mov_b64 exec, 1
    ds_write_b32 v49, v41 offset:6560
    ds_write_b32 v49, v42 offset:6564
    ds_add_u32 v53, v54 offset:6548
    s_mov_b64 exec, -1
    s_waitcnt vmcnt(11)
    s_cbranch_scc1 L_c150
    s_waitcnt vmcnt(7)
    s_cbranch_vccnz L_c150
    s_waitcnt vmcnt(4)
L_c150:
    buffer_load_dwordx4 v[252:255], v1, s[44:47], s60 offen offset:256 nt
    v_mfma_f32_16x16x32_bf16 v[28:31], v[32:35], v[204:207], v[28:31]
    s_waitcnt vmcnt(11)
    s_cbranch_scc1 L_c151
    s_waitcnt vmcnt(7)
    s_cbranch_vccnz L_c151
    s_waitcnt vmcnt(4)
L_c151:
    s_mov_b64 exec, 1
    s_waitcnt lgkmcnt(0)
    v_cmp_lt_i32 vcc, 201, v55
    v_readfirstlane_b32 s8, v55
    ds_add_rtn_u32 v55, v53, v54 offset:6556
    s_mov_b64 exec, -1
    s_add_u32 s60, s60, 12288
    s_cmp_eq_u32 s60, 393216
    s_cselect_b32 s60, 0, s60
    s_cmp_gt_i32 s8, 203
    buffer_load_dwordx4 v[88:91], v1, s[44:47], s60 offen offset:0 nt
    v_and_b32 v32, v71, v4
    v_and_b32 v33, v71, v5
    v_and_b32 v34, v71, v6
    v_and_b32 v35, v71, v7
    s_nop 1
    v_mfma_f32_16x16x32_bf16 v[20:23], v[32:35], v[208:211], v[20:23]
    s_waitcnt vmcnt(11)
    s_cbranch_scc1 L_c152
    s_waitcnt vmcnt(7)
    s_cbranch_vccnz L_c152
    s_waitcnt vmcnt(4)
L_c152:
    buffer_load_dwordx4 v[92:95], v1, s[44:47], s60 offen offset:128 nt
    v_mfma_f32_16x16x32_bf16 v[24:27], v[32:35], v[212:215], v[24:27]
    s_waitcnt vmcnt(11)
    s_cbranch_scc1 L_c153
    s_waitcnt vmcnt(7)
    s_cbranch_vccnz L_c153
    s_waitcnt vmcnt(4)
L_c153:
    buffer_load_dwordx4 v[96:99], v1, s[44:47], s60 offen offset:256 nt
    v_mfma_f32_16x16x32_bf16 v[28:31], v[32:35], v[216:219], v[28:31]
    s_cbranch_scc1 L_c154
    s_waitcnt vmcnt(9)
    s_cbranch_vccnz L_c154
    s_waitcnt vmcnt(4)
L_c154:
    s_mov_b64 exec, 1
    s_waitcnt lgkmcnt(0)
    v_cmp_lt_i32 vcc, 205, v55
    v_readfirstlane_b32 s8, v55
    ds_add_rtn_u32 v55, v53, v54 offset:6556
    s_mov_b64 exec, -1
    s_add_u32 s60, s60, 12288
    s_cmp_eq_u32 s60, 393216
    s_cselect_b32 s60, 0, s60
    s_cmp_gt_i32 s8, 207
    buffer_load_dwordx4 v[100:103], v1, s[44:47], s60 offen offset:0 nt
    s_cbranch_scc1 L_c155
    s_waitcnt vmcnt(9)
    s_cbranch_vccnz L_c155
    s_waitcnt vmcnt(4)
L_c155:
    buffer_load_dwordx4 v[104:107], v1, s[44:47], s60 offen offset:128 nt
    s_waitcnt vmcnt(13)
    s_cbranch_scc1 L_c156
    s_waitcnt vmcnt(9)
    s_cbranch_vccnz L_c156
    s_waitcnt vmcnt(4)
L_c156:
    buffer_load_dwordx4 v[108:111], v1, s[44:47], s60 offen offset:256 nt
    v_and_b32 v32, v72, v4
    v_and_b32 v33, v72, v5
    v_and_b32 v34, v72, v6
    v_and_b32 v35, v72, v7
    s_nop 1
    v_mfma_f32_16x16x32_bf16 v[20:23], v[32:35], v[220:223], v[20:23]
    s_waitcnt vmcnt(13)
    s_cbranch_scc1 L_c157
    s_waitcnt vmcnt(9)
    s_cbranch_vccnz L_c157
    s_waitcnt vmcnt(4)
L_c157:
    s_mov_b64 exec, 1
    s_waitcnt lgkmcnt(0)
    v_cmp_lt_i32 vcc, 209, v55
    v_readfirstlane_b32 s8, v55
    ds_add_rtn_u32 v55, v53, v54 offset:6556
    s_mov_b64 exec, -1
    s_add_u32 s60, s60, 12288
    s_cmp_eq_u32 s60, 393216
    s_cselect_b32 s60, 0, s60
    s_cmp_gt_i32 s8, 211
    buffer_load_dwordx4 v[112:115], v1, s[44:47], s60 offen offset:0 nt
    v_mfma_f32_16x16x32_bf16 v[24:27], v[32:35], v[224:227], v[24:27]
    s_waitcnt vmcnt(13)
    s_cbranch_scc1 L_c158
    s_waitcnt vmcnt(9)
    s_cbranch_vccnz L_c158
    s_waitcnt vmcnt(4)
L_c158:
    buffer_load_dwordx4 v[116:119], v1, s[44:47], s60 offen offset:128 nt
    v_mfma_f32_16x16x32_bf16 v[28:31], v[32:35], v[228:231], v[28:31]
    s_waitcnt vmcnt(13)
    s_cbranch_scc1 L_c159
    s_waitcnt vmcnt(9)
    s_cbranch_vccnz L_c159
    s_waitcnt vmcnt(4)
L_c159:
    buffer_load_dwordx4 v[120:123], v1, s[44:47], s60 offen offset:256 nt
    v_and_b32 v32, v73, v4
    v_and_b32 v33, v73, v5
    v_and_b32 v34, v73, v6
    v_and_b32 v35, v73, v7
    s_nop 1
    v_mfma_f32_16x16x32_bf16 v[20:23], v[32:35], v[232:235], v[20:23]
    s_waitcnt vmcnt(13)
    s_cbranch_scc1 L_c160
    s_waitcnt vmcnt(9)
    s_cbranch_vccnz L_c160
    s_waitcnt vmcnt(4)
L_c160:
    s_mov_b64 exec, 1
    s_waitcnt lgkmcnt(0)
    v_cmp_lt_i32 vcc, 213, v55
    v_readfirstlane_b32 s8, v55
    ds_add_rtn_u32 v55, v53, v54 offset:6556
    s_mov_b64 exec, -1
    s_add_u32 s60, s60, 12288
    s_cmp_eq_u32 s60, 393216
    s_cselect_b32 s60, 0, s60
    s_cmp_gt_i32 s8, 215
    buffer_load_dwordx4 v[124:127], v1, s[44:47], s60 offen offset:0 nt
    v_mfma_f32_16x16x32_bf16 v[24:27], v[32:35], v[236:239], v[24:27]
    s_waitcnt vmcnt(13)
    s_cbranch_scc1 L_c161
    s_waitcnt vmcnt(9)
    s_cbranch_vccnz L_c161
    s_waitcnt vmcnt(4)
L_c161:
    buffer_load_dwordx4 v[128:131], v1, s[44:47], s60 offen offset:128 nt
    v_mfma_f32_16x16x32_bf16 v[28:31], v[32:35], v[240:243], v[28:31]
    s_waitcnt vmcnt(13)
    s_cbranch_scc1 L_c162
    s_waitcnt vmcnt(9)
    s_cbranch_vccnz L_c162
    s_waitcnt vmcnt(4)
L_c162:
    buffer_load_dwordx4 v[132:135], v1, s[44:47], s60 offen offset:256 nt
    v_and_b32 v32, v74, v4
    v_and_b32 v33, v74, v5
    v_and_b32 v34, v74, v6
    v_and_b32 v35, v74, v7
    s_nop 1
    v_mfma_f32_16x16x32_bf16 v[20:23], v[32:35], v[244:247], v[20:23]
    s_waitcnt vmcnt(13)
    s_cbranch_scc1 L_c163
    s_waitcnt vmcnt(9)
    s_cbranch_vccnz L_c163
    s_waitcnt vmcnt(4)
L_c163:
    s_mov_b64 exec, 1
    s_waitcnt lgkmcnt(0)
    v_cmp_lt_i32 vcc, 217, v55
    v_readfirstlane_b32 s8, v55
    ds_add_rtn_u32 v55, v53, v54 offset:6556
    s_mov_b64 exec, -1
    s_add_u32 s60, s60, 12288
    s_cmp_eq_u32 s60, 393216
    s_cselect_b32 s60, 0, s60
    s_cmp_gt_i32 s8, 219
    buffer_load_dwordx4 v[136:139], v1, s[44:47], s60 offen offset:0 nt
    v_mfma_f32_16x16x32_bf16 v[24:27], v[32:35], v[248:251], v[24:27]
    s_waitcnt vmcnt(13)
    s_cbranch_scc1 L_c164
    s_waitcnt vmcnt(9)
    s_cbranch_vccnz L_c164
    s_waitcnt vmcnt(4)
L_c164:
    buffer_load_dwordx4 v[140:143], v1, s[44:47], s60 offen offset:128 nt
    v_mfma_f32_16x16x32_bf16 v[28:31], v[32:35], v[252:255], v[28:31]
    s_waitcnt vmcnt(13)
    s_cbranch_scc1 L_c165
    s_waitcnt vmcnt(9)
    s_cbranch_vccnz L_c165
    s_waitcnt vmcnt(4)
L_c165:
    buffer_load_dwordx4 v[144:147], v1, s[44:47], s60 offen offset:256 nt
    v_and_b32 v32, v75, v4
    v_and_b32 v33, v75, v5
    v_and_b32 v34, v75, v6
    v_and_b32 v35, v75, v7
    s_nop 1
    v_mfma_f32_16x16x32_bf16 v[20:23], v[32:35], v[88:91], v[20:23]
    s_waitcnt vmcnt(13)
    s_cbranch_scc1 L_c166
    s_waitcnt vmcnt(9)
    s_cbranch_vccnz L_c166
    s_waitcnt vmcnt(4)
L_c166:
    s_mov_b64 exec, 1
    s_waitcnt lgkmcnt(0)
    v_cmp_lt_i32 vcc, 221, v55
    v_readfirstlane_b32 s8, v55
    ds_add_rtn_u32 v55, v53, v54 offset:6556
    s_mov_b64 exec, -1
    s_add_u32 s60, s60, 12288
    s_cmp_eq_u32 s60, 393216
    s_cselect_b32 s60, 0, s60
    s_cmp_gt_i32 s8, 223
    buffer_load_dwordx4 v[148:151], v1, s[44:47], s60 offen offset:0 nt
    v_mfma_f32_16x16x32_bf16 v[24:27], v[32:35], v[92:95], v[24:27]
    s_waitcnt vmcnt(13)
    s_cbranch_scc1 L_c167
    s_waitcnt vmcnt(9)
    s_cbranch_vccnz L_c167
    s_waitcnt vmcnt(4)
L_c167:
    buffer_load_dwordx4 v[152:155], v1, s[44:47], s60 offen offset:128 nt
    v_mfma_f32_16x16x32_bf16 v[28:31], v[32:35], v[96:99], v[28:31]
    s_waitcnt vmcnt(13)
    s_cbranch_scc1 L_c168
    s_waitcnt vmcnt(9)
    s_cbranch_vccnz L_c168
    s_waitcnt vmcnt(4)
L_c168:
    buffer_load_dwordx4 v[156:159], v1, s[44:47], s60 offen offset:256 nt
    v_and_b32 v32, v76, v4
    v_and_b32 v33, v76, v5
    v_and_b32 v34, v76, v6
    v_and_b32 v35, v76, v7
    s_nop 1
    v_mfma_f32_16x16x32_bf16 v[20:23], v[32:35], v[100:103], v[20:23]
    s_waitcnt vmcnt(13)
    s_cbranch_scc1 L_c169
    s_waitcnt vmcnt(9)
    s_cbranch_vccnz L_c169
    s_waitcnt vmcnt(4)
L_c169:
    s_mov_b64 exec, 1
    s_waitcnt lgkmcnt(0)
    v_cmp_lt_i32 vcc, 225, v55
    v_readfirstlane_b32 s8, v55
    ds_add_rtn_u32 v55, v53, v54 offset:6556
    s_mov_b64 exec, -1
    s_add_u32 s60, s60, 12288
    s_cmp_eq_u32 s60, 393216
    s_cselect_b32 s60, 0, s60
    s_cmp_gt_i32 s8, 227
    buffer_load_dwordx4 v[160:163], v1, s[44:47], s60 offen offset:0 nt
    v_mfma_f32_16x16x32_bf16 v[24:27], v[32:35], v[104:107], v[24:27]
    s_waitcnt vmcnt(13)
    s_cbranch_scc1 L_c170
    s_waitcnt vmcnt(9)
    s_cbranch_vccnz L_c170
    s_waitcnt vmcnt(4)
L_c170:
    buffer_load_dwordx4 v[164:167], v1, s[44:47], s60 offen offset:128 nt
    v_mfma_f32_16x16x32_bf16 v[28:31], v[32:35], v[108:111], v[28:31]
    s_waitcnt vmcnt(13)
    s_cbranch_scc1 L_c171
    s_waitcnt vmcnt(9)
    s_cbranch_vccnz L_c171
    s_waitcnt vmcnt(4)
L_c171:
    buffer_load_dwordx4 v[168:171], v1, s[44:47], s60 offen offset:256 nt
    v_and_b32 v32, v77, v4
    v_and_b32 v33, v77, v5
    v_and_b32 v34, v77, v6
    v_and_b32 v35, v77, v7
    s_nop 1
    v_mfma_f32_16x16x32_bf16 v[20:23], v[32:35], v[112:115], v[20:23]
    s_waitcnt vmcnt(13)
    s_cbranch_scc1 L_c172
    s_waitcnt vmcnt(9)
    s_cbranch_vccnz L_c172
    s_waitcnt vmcnt(4)
L_c172:
    s_mov_b64 exec, 1
    s_waitcnt lgkmcnt(0)
    v_cmp_lt_i32 vcc, 229, v55
    v_readfirstlane_b32 s8, v55
    ds_add_rtn_u32 v55, v53, v54 offset:6556
    s_mov_b64 exec, -1
    s_add_u32 s60, s60, 12288
    s_cmp_eq_u32 s60, 393216
    s_cselect_b32 s60, 0, s60
    s_cmp_gt_i32 s8, 231
    buffer_load_dwordx4 v[172:175], v1, s[44:47], s60 offen offset:0 nt
    v_mfma_f32_16x16x32_bf16 v[24:27], v[32:35], v[116:119], v[24:27]
    s_waitcnt vmcnt(13)
    s_cbranch_scc1 L_c173
    s_waitcnt vmcnt(9)
    s_cbranch_vccnz L_c173
    s_waitcnt vmcnt(4)
L_c173:
    buffer_load_dwordx4 v[176:179], v1, s[44:47], s60 offen offset:128 nt
    v_mfma_f32_16x16x32_bf16 v[28:31], v[32:35], v[120:123], v[28:31]
    s_waitcnt vmcnt(13)
    s_cbranch_scc1 L_c174
    s_waitcnt vmcnt(9)
    s_cbranch_vccnz L_c174
    s_waitcnt vmcnt(4)
L_c174:
    buffer_load_dwordx4 v[180:183], v1, s[44:47], s60 offen offset:256 nt
    v_and_b32 v32, v78, v4
    v_and_b32 v33, v78, v5
    v_and_b32 v34, v78, v6
    v_and_b32 v35, v78, v7
    s_nop 1
    v_mfma_f32_16x16x32_bf16 v[20:23], v[32:35], v[124:127], v[20:23]
    s_waitcnt vmcnt(13)
    s_cbranch_scc1 L_c175
    s_waitcnt vmcnt(9)
    s_cbranch_vccnz L_c175
    s_waitcnt vmcnt(4)
L_c175:
    s_mov_b64 exec, 1
    s_waitcnt lgkmcnt(0)
    v_cmp_lt_i32 vcc, 233, v55
    v_readfirstlane_b32 s8, v55
    ds_add_rtn_u32 v55, v53, v54 offset:6556
    s_mov_b64 exec, -1
    s_add_u32 s60, s60, 12288
    s_cmp_eq_u32 s60, 393216
    s_cselect_b32 s60, 0, s60
    s_cmp_gt_i32 s8, 235
    buffer_load_dwordx4 v[184:187], v1, s[44:47], s60 offen offset:0 nt
    v_mfma_f32_16x16x32_bf16 v[24:27], v[32:35], v[128:131], v[24:27]
    s_waitcnt vmcnt(13)
    s_cbranch_scc1 L_c176
    s_waitcnt vmcnt(9)
    s_cbranch_vccnz L_c176
    s_waitcnt vmcnt(4)
L_c176:
    buffer_load_dwordx4 v[188:191], v1, s[44:47], s60 offen offset:128 nt
    v_mfma_f32_16x16x32_bf16 v[28:31], v[32:35], v[132:135], v[28:31]
    s_waitcnt vmcnt(13)
    s_cbranch_scc1 L_c177
    s_waitcnt vmcnt(9)
    s_cbranch_vccnz L_c177
    s_waitcnt vmcnt(4)
L_c177:
    buffer_load_dwordx4 v[192:195], v1, s[44:47], s60 offen offset:256 nt
    v_and_b32 v32, v79, v4
    v_and_b32 v33, v79, v5
    v_and_b32 v34, v79, v6
    v_and_b32 v35, v79, v7
    s_nop 1
    v_mfma_f32_16x16x32_bf16 v[20:23], v[32:35], v[136:139], v[20:23]
    s_waitcnt vmcnt(13)
    s_cbranch_scc1 L_c178
    s_waitcnt vmcnt(9)
    s_cbranch_vccnz L_c178
    s_waitcnt vmcnt(4)
L_c178:
    s_mov_b64 exec, 1
    s_waitcnt lgkmcnt(0)
    v_cmp_lt_i32 vcc, 237, v55
    v_readfirstlane_b32 s8, v55
    ds_add_rtn_u32 v55, v53, v54 offset:6556
    s_mov_b64 exec, -1
    s_add_u32 s60, s60, 12288
    s_cmp_eq_u32 s60, 393216
    s_cselect_b32 s60, 0, s60
    s_cmp_gt_i32 s8, 239
    buffer_load_dwordx4 v[196:199], v1, s[44:47], s60 offen offset:0 nt
    v_mfma_f32_16x16x32_bf16 v[24:27], v[32:35], v[140:143], v[24:27]
    s_waitcnt vmcnt(13)
    s_cbranch_scc1 L_c179
    s_waitcnt vmcnt(9)
    s_cbranch_vccnz L_c179
    s_waitcnt vmcnt(4)
L_c179:
    buffer_load_dwordx4 v[200:203], v1, s[44:47], s60 offen offset:128 nt
    v_mfma_f32_16x16x32_bf16 v[28:31], v[32:35], v[144:147], v[28:31]
    s_waitcnt vmcnt(13)
    s_cbranch_scc1 L_c180
    s_waitcnt vmcnt(9)
    s_cbranch_vccnz L_c180
    s_waitcnt vmcnt(4)
L_c180:
    buffer_load_dwordx4 v[204:207], v1, s[44:47], s60 offen offset:256 nt
    v_and_b32 v32, v80, v4
    v_and_b32 v33, v80, v5
    v_and_b32 v34, v80, v6
    v_and_b32 v35, v80, v7
    s_nop 1
    v_mfma_f32_16x16x32_bf16 v[20:23], v[32:35], v[148:151], v[20:23]
    s_waitcnt vmcnt(13)
    s_cbranch_scc1 L_c181
    s_waitcnt vmcnt(9)
    s_cbranch_vccnz L_c181
    s_waitcnt vmcnt(4)
L_c181:
    s_mov_b64 exec, 1
    s_waitcnt lgkmcnt(0)
    v_cmp_lt_i32 vcc, 241, v55
    v_readfirstlane_b32 s8, v55
    ds_add_rtn_u32 v55, v53, v54 offset:6556
    s_mov_b64 exec, -1
    s_add_u32 s60, s60, 12288
    s_cmp_eq_u32 s60, 393216
    s_cselect_b32 s60, 0, s60
    s_cmp_gt_i32 s8, 243
    buffer_load_dwordx4 v[208:211], v1, s[44:47], s60 offen offset:0 nt
    v_mfma_f32_16x16x32_bf16 v[24:27], v[32:35], v[152:155], v[24:27]
    s_waitcnt vmcnt(13)
    s_cbranch_scc1 L_c182
    s_waitcnt vmcnt(9)
    s_cbranch_vccnz L_c182
    s_waitcnt vmcnt(4)
L_c182:
    buffer_load_dwordx4 v[212:215], v1, s[44:47], s60 offen offset:128 nt
    v_mfma_f32_16x16x32_bf16 v[28:31], v[32:35], v[156:159], v[28:31]
    s_waitcnt vmcnt(13)
    s_cbranch_scc1 L_c183
    s_waitcnt vmcnt(9)
    s_cbranch_vccnz L_c183
    s_waitcnt vmcnt(4)
L_c183:
    buffer_load_dwordx4 v[216:219], v1, s[44:47], s60 offen offset:256 nt
    v_and_b32 v32, v81, v4
    v_and_b32 v33, v81, v5
    v_and_b32 v34, v81, v6
    v_and_b32 v35, v81, v7
    s_nop 1
    v_mfma_f32_16x16x32_bf16 v[20:23], v[32:35], v[160:163], v[20:23]
    s_waitcnt vmcnt(13)
    s_cbranch_scc1 L_c184
    s_waitcnt vmcnt(9)
    s_cbranch_vccnz L_c184
    s_waitcnt vmcnt(4)
L_c184:
    s_mov_b64 exec, 1
    s_waitcnt lgkmcnt(0)
    v_cmp_lt_i32 vcc, 245, v55
    v_readfirstlane_b32 s8, v55
    ds_add_rtn_u32 v55, v53, v54 offset:6556
    s_mov_b64 exec, -1
    s_add_u32 s60, s60, 12288
    s_cmp_eq_u32 s60, 393216
    s_cselect_b32 s60, 0, s60
    s_cmp_gt_i32 s8, 247
    buffer_load_dwordx4 v[220:223], v1, s[44:47], s60 offen offset:0 nt
    v_mfma_f32_16x16x32_bf16 v[24:27], v[32:35], v[164:167], v[24:27]
    s_waitcnt vmcnt(13)
    s_cbranch_scc1 L_c185
    s_waitcnt vmcnt(9)
    s_cbranch_vccnz L_c185
    s_waitcnt vmcnt(4)
L_c185:
    buffer_load_dwordx4 v[224:227], v1, s[44:47], s60 offen offset:128 nt
    v_mfma_f32_16x16x32_bf16 v[28:31], v[32:35], v[168:171], v[28:31]
    s_waitcnt vmcnt(13)
    s_cbranch_scc1 L_c186
    s_waitcnt vmcnt(9)
    s_cbranch_vccnz L_c186
    s_waitcnt vmcnt(4)
L_c186:
    buffer_load_dwordx4 v[228:231], v1, s[44:47], s60 offen offset:256 nt
    v_and_b32 v32, v82, v4
    v_and_b32 v33, v82, v5
    v_and_b32 v34, v82, v6
    v_and_b32 v35, v82, v7
    s_nop 1
    v_mfma_f32_16x16x32_bf16 v[20:23], v[32:35], v[172:175], v[20:23]
    s_waitcnt vmcnt(13)
    s_cbranch_scc1 L_c187
    s_waitcnt vmcnt(9)
    s_cbranch_vccnz L_c187
    s_waitcnt vmcnt(4)
L_c187:
    s_mov_b64 exec, 1
    s_waitcnt lgkmcnt(0)
    v_cmp_lt_i32 vcc, 249, v55
    v_readfirstlane_b32 s8, v55
    ds_add_rtn_u32 v55, v53, v54 offset:6556
    s_mov_b64 exec, -1
    s_add_u32 s60, s60, 12288
    s_cmp_eq_u32 s60, 393216
    s_cselect_b32 s60, 0, s60
    s_cmp_gt_i32 s8, 251
    buffer_load_dwordx4 v[232:235], v1, s[44:47], s60 offen offset:0 nt
    v_mfma_f32_16x16x32_bf16 v[24:27], v[32:35], v[176:179], v[24:27]
    s_waitcnt vmcnt(13)
    s_cbranch_scc1 L_c188
    s_waitcnt vmcnt(9)
    s_cbranch_vccnz L_c188
    s_waitcnt vmcnt(4)
L_c188:
    buffer_load_dwordx4 v[236:239], v1, s[44:47], s60 offen offset:128 nt
    v_mfma_f32_16x16x32_bf16 v[28:31], v[32:35], v[180:183], v[28:31]
    s_waitcnt vmcnt(13)
    s_cbranch_scc1 L_c189
    s_waitcnt vmcnt(9)
    s_cbranch_vccnz L_c189
    s_waitcnt vmcnt(4)
L_c189:
    buffer_load_dwordx4 v[240:243], v1, s[44:47], s60 offen offset:256 nt
    v_and_b32 v32, v83, v4
    v_and_b32 v33, v83, v5
    v_and_b32 v34, v83, v6
    v_and_b32 v35, v83, v7
    s_nop 1
    v_mfma_f32_16x16x32_bf16 v[20:23], v[32:35], v[184:187], v[20:23]
    s_waitcnt vmcnt(13)
    v_mfma_f32_16x16x32_bf16 v[24:27], v[32:35], v[188:191], v[24:27]
    s_waitcnt vmcnt(12)
    v_mfma_f32_16x16x32_bf16 v[28:31], v[32:35], v[192:195], v[28:31]
    s_waitcnt vmcnt(11)
    v_and_b32 v32, v84, v4
    v_and_b32 v33, v84, v5
    v_and_b32 v34, v84, v6
    v_and_b32 v35, v84, v7
    s_nop 1
    v_mfma_f32_16x16x32_bf16 v[20:23], v[32:35], v[196:199], v[20:23]
    s_waitcnt vmcnt(10)
    v_mfma_f32_16x16x32_bf16 v[24:27], v[32:35], v[200:203], v[24:27]
    s_waitcnt vmcnt(9)
    v_mfma_f32_16x16x32_bf16 v[28:31], v[32:35], v[204:207], v[28:31]
    s_waitcnt vmcnt(8)
    v_and_b32 v32, v85, v4
    v_and_b32 v33, v85, v5
    v_and_b32 v34, v85, v6
    v_and_b32 v35, v85, v7
    s_nop 1
    v_mfma_f32_16x16x32_bf16 v[20:23], v[32:35], v[208:211], v[20:23]
    s_waitcnt vmcnt(7)
    v_mfma_f32_16x16x32_bf16 v[24:27], v[32:35], v[212:215], v[24:27]
    s_waitcnt vmcnt(6)
    v_mfma_f32_16x16x32_bf16 v[28:31], v[32:35], v[216:219], v[28:31]
    s_waitcnt vmcnt(5)
    v_and_b32 v32, v86, v4
    v_and_b32 v33, v86, v5
    v_and_b32 v34, v86, v6
    v_and_b32 v35, v86, v7
    s_nop 1
    v_mfma_f32_16x16x32_bf16 v[20:23], v[32:35], v[220:223], v[20:23]
    s_waitcnt vmcnt(4)
    v_mfma_f32_16x16x32_bf16 v[24:27], v[32:35], v[224:227], v[24:27]
    s_waitcnt vmcnt(3)
    v_mfma_f32_16x16x32_bf16 v[28:31], v[32:35], v[228:231], v[28:31]
    s_mov_b32 s60, 0
    buffer_load_dwordx4 v[244:247], v3, s[48:51], s60 offen offset:0 nt
    s_waitcnt vmcnt(3)
    v_and_b32 v32, v87, v4
    v_and_b32 v33, v87, v5
    v_and_b32 v34, v87, v6
    v_and_b32 v35, v87, v7
    s_nop 1
    v_mfma_f32_16x16x32_bf16 v[20:23], v[32:35], v[232:235], v[20:23]
    buffer_load_dwordx4 v[248:251], v3, s[48:51], s60 offen offset:1280 nt
    s_waitcnt vmcnt(3)
    v_mfma_f32_16x16x32_bf16 v[24:27], v[32:35], v[236:239], v[24:27]
    buffer_load_dwordx4 v[252:255], v3, s[48:51], s60 offen offset:2560 nt
    s_waitcnt vmcnt(3)
    v_mfma_f32_16x16x32_bf16 v[28:31], v[32:35], v[240:243], v[28:31]
    s_mov_b32 exec_lo, 0x00ff00ff
    s_mov_b32 exec_hi, 0xff00ff00
    ds_write_b128 v37, v[20:23] offset:0
    s_nop 1
    ds_write_b128 v37, v[24:27] offset:256
    s_nop 1
    ds_write_b128 v37, v[28:31] offset:512
    s_mov_b64 exec, 1
    ds_add_u32 v53, v54 offset:6552
    s_mov_b64 exec, -1
    buffer_load_dwordx4 v[88:91], v3, s[48:51], s60 offen offset:3840 nt
    v_and_b32 v49, 7, v0
    v_lshlrev_b32 v43, 4, v49
    v_bfe_u32 v49, v0, 4, 1
    v_lshl_add_u32 v43, v49, 3, v43
    v_lshrrev_b32 v49, 5, v0
    v_lshl_add_u32 v43, v49, 2, v43
    v_bfe_u32 v49, v0, 3, 1
    v_lshl_add_u32 v43, v49, 1, v43
    s_mul_i32 s3, s12, 1280
    s_add_u32 s3, s3, s96
    v_add_u32 v43, s3, v43
    s_mov_b32 s19, 4000000
L_h:
    ds_read_b32 v49, v53 offset:7876
    s_sub_u32 s19, s19, 1
    s_cbranch_scc1 L_hx
    s_waitcnt lgkmcnt(0)
    v_readfirstlane_b32 s3, v49
    s_cmp_eq_u32 s3, 0
    s_cbranch_scc1 L_h
L_hx:
    s_mov_b32 s60, 5120
    buffer_load_dwordx4 v[92:95], v3, s[48:51], s60 offen offset:0 nt
    buffer_load_dwordx4 v[96:99], v3, s[48:51], s60 offen offset:1280 nt
    s_waitcnt vmcnt(5)
    buffer_load_dwordx4 v[100:103], v3, s[48:51], s60 offen offset:2560 nt
    s_mov_b64 exec, 1
    ds_add_u32 v53, v54 offset:7880
    s_mov_b64 exec, -1
    s_waitcnt vmcnt(5)
    buffer_load_dwordx4 v[104:107], v3, s[48:51], s60 offen offset:3840 nt
    s_mov_b64 exec, 1
    ds_add_u32 v53, v54 offset:7880
    s_mov_b64 exec, -1
    s_waitcnt vmcnt(5)
    s_mov_b32 s60, 10240
    buffer_load_dwordx4 v[108:111], v3, s[48:51], s60 offen offset:0 nt
    s_mov_b64 exec, 1
    ds_add_u32 v53, v54 offset:7880
    s_mov_b64 exec, -1
    s_waitcnt vmcnt(5)
    buffer_load_dwordx4 v[112:115], v3, s[48:51], s60 offen offset:1280 nt
    s_mov_b64 exec, 1
    ds_add_u32 v53, v54 offset:7880
    s_mov_b64 exec, -1
    s_waitcnt vmcnt(5)
    buffer_load_dwordx4 v[116:119], v3, s[48:51], s60 offen offset:2560 nt
    s_mov_b64 exec, 1
    ds_add_u32 v53, v54 offset:7880
    s_mov_b64 exec, -1
    s_waitcnt vmcnt(5)
    buffer_load_dwordx4 v[120:123], v3, s[48:51], s60 offen offset:3840 nt
    s_mov_b64 exec, 1
    ds_add_u32 v53, v54 offset:7880
    s_mov_b64 exec, -1
L_tail:
    s_barrier
    ds_read_b128 v[8:11], v39 offset:0
    ds_read_b128 v[12:15], v39 offset:16
    ds_read_b128 v[16:19], v39 offset:32
    s_mov_b32 s32, 0
    s_mov_b32 s33, 0x43300010
    s_mov_b32 s34, 0
    s_mov_b32 s35, 0xc3300400
    ds_read_b128 v[28:31], v53 offset:7888
    s_mov_b32 vcc_lo, 0x00ff00ff
    s_mov_b32 vcc_hi, 0xff00ff00
    s_waitcnt lgkmcnt(1)
    v_and_b32 v32, v8, v4
    v_and_b32 v33, v8, v5
    v_and_b32 v34, v8, v6
    v_and_b32 v35, v8, v7
    v_and_b32 v48, v9, v4
    v_and_b32 v49, v9, v5
    v_and_b32 v50, v9, v6
    v_and_b32 v51, v9, v7
    v_mfma_f32_16x16x32_bf16 v[20:23], v[32:35], v[244:247], 0
    v_and_b32 v32, v10, v4
    v_and_b32 v33, v10, v5
    v_and_b32 v34, v10, v6
    v_and_b32 v35, v10, v7
    v_mfma_f32_16x16x32_bf16 v[20:23], v[48:51], v[248:251], v[20:23]
    v_and_b32 v48, v11, v4
    v_and_b32 v49, v11, v5
    v_and_b32 v50, v11, v6
    v_and_b32 v51, v11, v7
    v_mfma_f32_16x16x32_bf16 v[20:23], v[32:35], v[252:255], v[20:23]
    v_and_b32 v32, v12, v4
    v_and_b32 v33, v12, v5
    v_and_b32 v34, v12, v6
    v_and_b32 v35, v12, v7
    v_mfma_f32_16x16x32_bf16 v[20:23], v[48:51], v[88:91], v[20:23]
    v_and_b32 v48, v13, v4
    v_and_b32 v49, v13, v5
    v_and_b32 v50, v13, v6
    v_and_b32 v51, v13, v7
    v_mfma_f32_16x16x32_bf16 v[20:23], v[32:35], v[92:95], v[20:23]
    v_and_b32 v32, v14, v4
    v_and_b32 v33, v14, v5
    v_and_b32 v34, v14, v6
    v_and_b32 v35, v14, v7
    v_mfma_f32_16x16x32_bf16 v[20:23], v[48:51], v[96:99], v[20:23]
    v_and_b32 v48, v15, v4
    v_and_b32 v49, v15, v5
    v_and_b32 v50, v15, v6
    v_and_b32 v51, v15, v7
    s_waitcnt vmcnt(5)
    v_mfma_f32_16x16x32_bf16 v[20:23], v[32:35], v[100:103], v[20:23]
    v_and_b32 v32, v16, v4
    v_and_b32 v33, v16, v5
    v_and_b32 v34, v16, v6
    v_and_b32 v35, v16, v7
    s_waitcnt vmcnt(4)
    v_mfma_f32_16x16x32_bf16 v[20:23], v[48:51], v[104:107], v[20:23]
    v_and_b32 v48, v17, v4
    v_and_b32 v49, v17, v5
    v_and_b32 v50, v17, v6
    v_and_b32 v51, v17, v7
    s_waitcnt vmcnt(3)
    v_mfma_f32_16x16x32_bf16 v[20:23], v[32:35], v[108:111], v[20:23]
    v_and_b32 v32, v18, v4
    v_and_b32 v33, v18, v5
    v_and_b32 v34, v18, v6
    v_and_b32 v35, v18, v7
    s_waitcnt vmcnt(2)
    v_mfma_f32_16x16x32_bf16 v[20:23], v[48:51], v[112:115], v[20:23]
    v_and_b32 v48, v19, v4
    v_and_b32 v49, v19, v5
    v_and_b32 v50, v19, v6
    v_and_b32 v51, v19, v7
    s_waitcnt vmcnt(1)
    v_mfma_f32_16x16x32_bf16 v[20:23], v[32:35], v[116:119], v[20:23]
    s_waitcnt vmcnt(0)
    v_mfma_f32_16x16x32_bf16 v[20:23], v[48:51], v[120:123], v[20:23]
    s_waitcnt lgkmcnt(0)
    v_mul_f32 v8, 0x51800000, v30
    v_mul_f32 v9, 0x47800000, v30
    v_mov_b32 v10, 0xbed00000
    v_mov_b32 v11, 0xbed00800
    v_mov_b32 v14, 0x2040010
    s_nop 1
    v_cndmask_b32_dpp v20, v21, v20, vcc row_ror:8 row_mask:0xf bank_mask:0xf
    v_cndmask_b32_dpp v22, v23, v22, vcc row_ror:8 row_mask:0xf bank_mask:0xf
    s_nop 1
    v_permlane32_swap_b32 v20, v22
    s_nop 1
    v_add_f32_dpp v20, v22, v20 row_ror:8 row_mask:0xf bank_mask:0xf
    v_cvt_f64_f32 v[32:33], v20
    v_cmp_lt_f32 s[36:37], |v20|, v9
    v_cmp_lt_f32 vcc, |v20|, v8
    v_fma_f64 v[32:33], v[32:33], v[28:29], s[32:33]
    v_cndmask_b32 v10, v10, v11, s[36:37]
    v_cndmask_b32 v32, 0, v32, vcc
    v_add_u32 v33, v33, v10
    v_cndmask_b32 v33, v14, v33, vcc
    global_atomic_add_x2 v[34:35], v40, v[32:33], s[30:31] sc0 sc1
    s_lshr_b32 s3, s96, 7
    s_mul_i32 s4, s12, 10
    s_add_u32 s3, s3, s4
    s_lshl_b32 s3, s3, 15
    s_add_u32 s3, s3, 462848
    v_lshl_add_u32 v41, v0, 3, s3
    v_mov_b32 v21, v31
    v_mov_b32 v37, v31
    v_mov_b32 v12, 0x43300000
    s_movk_i32 s38, 0x7ff
    s_orn2_b64 s[36:37], s[36:37], vcc
    s_cbranch_scc1 L_raw
    s_waitcnt vmcnt(0)
L_got:
    v_lshl_add_u64 v[34:35], v[34:35], 0, v[32:33]
    v_cmp_gt_i32 vcc, 0, v35
    v_bfe_u32 v13, v35, 11, 14
    v_and_or_b32 v35, v35, s38, v12
    s_and_b64 exec, exec, vcc
    s_cbranch_scc0 L_atx
    v_add_f64 v[34:35], v[34:35], s[34:35]
    v_cvt_f32_f64 v49, v[34:35]
    v_mul_f32 v49, v30, v49
    v_cvt_pk_bf16_f32 v50, v49, v49
    buffer_store_short v50, v43, s[56:59], 0 offen
    s_cmp_eq_u32 s96, 0
    s_cselect_b32 s3, exec_lo, 0
    s_and_b32 s3, s3, 1
    s_cbranch_scc0 L_att
    s_mov_b64 s[36:37], exec
    s_mov_b64 exec, 1
    s_lshl_b32 s3, s12, 7
    buffer_store_dwordx2 v[36:37], v53, s[52:55], s3 offen sc1
    s_mov_b64 exec, s[36:37]
L_att:
    v_cmp_le_u32 vcc, 64, v13
    s_and_b64 exec, exec, vcc
    s_cbranch_scc0 L_atx
    v_and_b32 v50, 127, v13
    v_lshrrev_b32 v10, 7, v13
    v_add_u32 v50, v50, v10
    v_cmp_eq_u32 vcc, 64, v50
    s_nop 1
    v_cndmask_b32 v10, v10, v50, vcc
    v_mov_b32 v50, -1.0
    v_cndmask_b32 v8, v8, v50, vcc
    v_mov_b32 v50, 0
    v_cndmask_b32 v49, v49, v50, vcc
    s_mov_b32 s19, 50000
L_atr:
    v_mov_b32 v11, 0
    v_mov_b32 v12, v49
    s_mov_b32 s60, 0
L_atf:
    buffer_load_dwordx2 v[88:89], v41, s[52:55], s60 offen offset:0 sc1
    buffer_load_dwordx2 v[90:91], v41, s[52:55], s60 offen offset:512 sc1
    buffer_load_dwordx2 v[92:93], v41, s[52:55], s60 offen offset:1024 sc1
    buffer_load_dwordx2 v[94:95], v41, s[52:55], s60 offen offset:1536 sc1
    buffer_load_dwordx2 v[96:97], v41, s[52:55], s60 offen offset:2048 sc1
    buffer_load_dwordx2 v[98:99], v41, s[52:55], s60 offen offset:2560 sc1
    buffer_load_dwordx2 v[100:101], v41, s[52:55], s60 offen offset:3072 sc1
    buffer_load_dwordx2 v[102:103], v41, s[52:55], s60 offen offset:3584 sc1
    s_waitcnt vmcnt(0)
    v_cmp_eq_u32 vcc, v89, v31
    v_cmp_nlt_f32 s[36:37], |v88|, v8
    s_and_b64 vcc, vcc, s[36:37]
    v_cndmask_b32 v88, 0, v88, vcc
    v_cndmask_b32 v89, 0, 1, vcc
    v_add_f32 v12, v12, v88
    v_add_u32 v11, v11, v89
    v_cmp_eq_u32 vcc, v91, v31
    v_cmp_nlt_f32 s[36:37], |v90|, v8
    s_and_b64 vcc, vcc, s[36:37]
    v_cndmask_b32 v90, 0, v90, vcc
    v_cndmask_b32 v91, 0, 1, vcc
    v_add_f32 v12, v12, v90
    v_add_u32 v11, v11, v91
    v_cmp_eq_u32 vcc, v93, v31
    v_cmp_nlt_f32 s[36:37], |v92|, v8
    s_and_b64 vcc, vcc, s[36:37]
    v_cndmask_b32 v92, 0, v92, vcc
    v_cndmask_b32 v93, 0, 1, vcc
    v_add_f32 v12, v12, v92
    v_add_u32 v11, v11, v93
    v_cmp_eq_u32 vcc, v95, v31
    v_cmp_nlt_f32 s[36:37], |v94|, v8
    s_and_b64 vcc, vcc, s[36:37]
    v_cndmask_b32 v94, 0, v94, vcc
    v_cndmask_b32 v95, 0, 1, vcc
    v_add_f32 v12, v12, v94
    v_add_u32 v11, v11, v95
    v_cmp_eq_u32 vcc, v97, v31
    v_cmp_nlt_f32 s[36:37], |v96|, v8
    s_and_b64 vcc, vcc, s[36:37]
    v_cndmask_b32 v96, 0, v96, vcc
    v_cndmask_b32 v97, 0, 1, vcc
    v_add_f32 v12, v12, v96
    v_add_u32 v11, v11, v97
    v_cmp_eq_u32 vcc, v99, v31
    v_cmp_nlt_f32 s[36:37], |v98|, v8
    s_and_b64 vcc, vcc, s[36:37]
    v_cndmask_b32 v98, 0, v98, vcc
    v_cndmask_b32 v99, 0, 1, vcc
    v_add_f32 v12, v12, v98
    v_add_u32 v11, v11, v99
    v_cmp_eq_u32 vcc, v101, v31
    v_cmp_nlt_f32 s[36:37], |v100|, v8
    s_and_b64 vcc, vcc, s[36:37]
    v_cndmask_b32 v100, 0, v100, vcc
    v_cndmask_b32 v101, 0, 1, vcc
    v_add_f32 v12, v12, v100
    v_add_u32 v11, v11, v101
    v_cmp_eq_u32 vcc, v103, v31
    v_cmp_nlt_f32 s[36:37], |v102|, v8
    s_and_b64 vcc, vcc, s[36:37]
    v_cndmask_b32 v102, 0, v102, vcc
    v_cndmask_b32 v103, 0, 1, vcc
    v_add_f32 v12, v12, v102
    v_add_u32 v11, v11, v103
    s_add_u32 s60, s60, 4096
    s_cmp_lt_u32 s60, 32768
    s_cbranch_scc1 L_atf
    v_cvt_pk_bf16_f32 v50, v12, v12
    buffer_store_short v50, v43, s[56:59], 0 offen
    v_cmp_ne_u32 vcc, v11, v10
    s_and_b64 exec, exec, vcc
    s_cbranch_scc0 L_atx
    s_sub_u32 s19, s19, 1
    s_cbranch_scc0 L_atr
    s_branch L_atx
L_raw:
    s_lshl_b32 s3, s13, 1
    s_add_u32 s3, s3, s98
    s_lshl_b32 s3, s3, 9
    s_mov_b64 exec, s[36:37]
    buffer_store_dwordx2 v[20:21], v41, s[52:55], s3 offen sc1
    s_mov_b64 exec, -1
    s_waitcnt vmcnt(1)
    s_branch L_got
L_atx:
    s_mov_b64 exec, -1
    s_endpgm
L_six:
    s_waitcnt lgkmcnt(0)
    s_barrier
    v_and_b32 v49, 1, v0
    v_lshlrev_b32 v49, 4, v49
    v_mov_b32 v50, 0xffff
    v_lshlrev_b32 v49, v49, v50
    v_bfe_u32 v50, v0, 1, 2
    v_cmp_eq_u32 vcc, 0, v50
    s_nop 1
    v_cndmask_b32 v4, 0, v49, vcc
    v_cmp_eq_u32 vcc, 1, v50
    s_nop 1
    v_cndmask_b32 v5, 0, v49, vcc
    v_cmp_eq_u32 vcc, 2, v50
    s_nop 1
    v_cndmask_b32 v6, 0, v49, vcc
    v_cmp_eq_u32 vcc, 3, v50
    s_nop 1
    v_cndmask_b32 v7, 0, v49, vcc
    v_lshrrev_b32 v49, 3, v0
    v_and_b32 v50, 7, v0
    v_mul_u32_u24 v3, 15360, v49
    v_lshl_add_u32 v3, v50, 4, v3
    s_mul_i32 s7, s98, 384
    s_add_u32 s7, s7, 6592
    v_mul_u32_u24 v39, 48, v49
    v_add_u32 v39, s7, v39
    v_mul_u32_u24 v40, 256, v49
    v_lshl_add_u32 v40, v50, 3, v40
    s_lshr_b32 s7, s96, 7
    s_mul_i32 s8, s12, 10
    s_add_u32 s7, s7, s8
    s_mul_i32 s7, s7, 2048
    s_add_u32 s7, s7, 2691072
    v_add_u32 v40, s7, v40
    v_mov_b32 v53, 0
    v_mov_b32 v54, 1
    s_mov_b32 s62, 117835008
    s_mov_b32 s63, 117835009
    s_mov_b32 s64, 117835010
    s_mov_b32 s65, 117835011
    s_add_u32 s48, s26, s6
    s_addc_u32 s49, s27, 0
    s_sub_u32 s50, 7864320, s6
    s_mov_b32 s51, 0x20000
    s_mov_b32 s52, s30
    s_mov_b32 s53, s31
    s_mov_b32 s54, 2732032
    s_mov_b32 s55, 0x20000
    s_mov_b32 s56, s28
    s_mov_b32 s57, s29
    s_mov_b32 s58, 2560
    s_mov_b32 s59, 0x20000
    v_and_b32 v49, 7, v0
    v_lshlrev_b32 v43, 4, v49
    v_bfe_u32 v49, v0, 4, 1
    v_lshl_add_u32 v43, v49, 3, v43
    v_lshrrev_b32 v49, 5, v0
    v_lshl_add_u32 v43, v49, 2, v43
    v_bfe_u32 v49, v0, 3, 1
    v_lshl_add_u32 v43, v49, 1, v43
    s_mul_i32 s3, s12, 1280
    s_add_u32 s3, s3, s96
    v_add_u32 v43, s3, v43
    s_mov_b32 s19, 4000000
L_6a:
    ds_read_b32 v49, v53 offset:6552
    s_sub_u32 s19, s19, 1
    s_cbranch_scc1 L_6ax
    s_waitcnt lgkmcnt(0)
    v_readfirstlane_b32 s3, v49
    s_cmp_lt_i32 s3, 1
    s_cbranch_scc1 L_6a
L_6ax:
    s_mov_b32 s60, 0
    buffer_load_dwordx4 v[244:247], v3, s[48:51], s60 offen offset:0 nt
    buffer_load_dwordx4 v[248:251], v3, s[48:51], s60 offen offset:1280 nt
    buffer_load_dwordx4 v[252:255], v3, s[48:51], s60 offen offset:2560 nt
    buffer_load_dwordx4 v[88:91], v3, s[48:51], s60 offen offset:3840 nt
    s_mov_b32 s19, 4000000
L_6b:
    ds_read_b32 v49, v53 offset:7876
    s_sub_u32 s19, s19, 1
    s_cbranch_scc1 L_6bx
    s_waitcnt lgkmcnt(0)
    v_readfirstlane_b32 s3, v49
    s_cmp_eq_u32 s3, 0
    s_cbranch_scc1 L_6b
L_6bx:
    ds_read_b32 v36, v53 offset:6528
    s_mov_b32 s60, 5120
    buffer_load_dwordx4 v[92:95], v3, s[48:51], s60 offen offset:0 nt
    buffer_load_dwordx4 v[96:99], v3, s[48:51], s60 offen offset:1280 nt
    s_waitcnt vmcnt(5)
    buffer_load_dwordx4 v[100:103], v3, s[48:51], s60 offen offset:2560 nt
    s_mov_b64 exec, 1
    ds_add_u32 v53, v54 offset:7880
    s_mov_b64 exec, -1
    s_waitcnt vmcnt(5)
    buffer_load_dwordx4 v[104:107], v3, s[48:51], s60 offen offset:3840 nt
    s_mov_b64 exec, 1
    ds_add_u32 v53, v54 offset:7880
    s_mov_b64 exec, -1
    s_waitcnt vmcnt(5)
    s_mov_b32 s60, 10240
    buffer_load_dwordx4 v[108:111], v3, s[48:51], s60 offen offset:0 nt
    s_mov_b64 exec, 1
    ds_add_u32 v53, v54 offset:7880
    s_mov_b64 exec, -1
    s_waitcnt vmcnt(5)
    buffer_load_dwordx4 v[112:115], v3, s[48:51], s60 offen offset:1280 nt
    s_mov_b64 exec, 1
    ds_add_u32 v53, v54 offset:7880
    s_mov_b64 exec, -1
    s_waitcnt vmcnt(5)
    buffer_load_dwordx4 v[116:119], v3, s[48:51], s60 offen offset:2560 nt
    s_mov_b64 exec, 1
    ds_add_u32 v53, v54 offset:7880
    s_mov_b64 exec, -1
    s_waitcnt vmcnt(5)
    buffer_load_dwordx4 v[120:123], v3, s[48:51], s60 offen offset:3840 nt
    s_mov_b64 exec, 1
    ds_add_u32 v53, v54 offset:7880
    s_mov_b64 exec, -1
    s_branch L_tail
L_other:
    s_load_dwordx2 s[26:27], s[0:1], s7 offset:32
    s_load_dwordx2 s[28:29], s[0:1], 80
    s_load_dwordx2 s[30:31], s[0:1], 96
    s_bfe_u32 s10, s2, 0x20003
    s_lshr_b32 s14, s14, 6
    v_and_b32 v0, 63, v0
    s_lshl_b32 s15, s13, 2
    s_add_u32 s15, s15, s10
    s_min_u32 s97, s14, 4
    s_and_b32 s62, s10, 1
    s_mul_i32 s63, s62, 3
    s_bfe_u32 s64, s97, 0x10001
    s_add_u32 s63, s63, s64
    s_and_b32 s64, s97, 1
    s_cmp_eq_u32 s97, 0
    s_cselect_b32 s63, 2, s63
    s_cselect_b32 s98, s62, s64
    s_lshr_b32 s62, s10, 1
    s_mul_i32 s62, s62, 5
    s_add_u32 s63, s63, s62
    s_lshl_b32 s63, s63, 7
    s_mov_b32 s96, s63
    s_mul_i32 s6, s13, 245760
    s_add_u32 s6, s6, s63
    s_mul_i32 s62, s98, 122880
    s_add_u32 s6, s6, s62
    s_cmp_eq_u32 s14, 5
    s_cbranch_scc1 L_six
L_service:
    s_nop 4
    s_setprio 3
    v_mov_b32 v53, 0
    ds_write_b32 v53, v53 offset:6544
    ds_write_b32 v53, v53 offset:6548
    ds_write_b32 v53, v53 offset:6552
    ds_write_b32 v53, v53 offset:6556
    ds_write_b32 v53, v53 offset:6532
    ds_write_b32 v53, v53 offset:7872
    ds_write_b32 v53, v53 offset:8128
    ds_write_b32 v53, v53 offset:7876
    ds_write_b32 v53, v53 offset:7880
    s_waitcnt lgkmcnt(0)
    s_mov_b64 s[22:23], s[44:45]
    v_and_b32 v49, 1, v0
    v_lshlrev_b32 v49, 4, v49
    v_mov_b32 v50, 0xffff
    v_lshlrev_b32 v49, v49, v50
    v_bfe_u32 v50, v0, 1, 2
    v_cmp_eq_u32 vcc, 0, v50
    s_nop 1
    v_cndmask_b32 v4, 0, v49, vcc
    v_cmp_eq_u32 vcc, 1, v50
    s_nop 1
    v_cndmask_b32 v5, 0, v49, vcc
    v_cmp_eq_u32 vcc, 2, v50
    s_nop 1
    v_cndmask_b32 v6, 0, v49, vcc
    v_cmp_eq_u32 vcc, 3, v50
    s_nop 1
    v_cndmask_b32 v7, 0, v49, vcc
    v_lshrrev_b32 v49, 3, v0
    v_and_b32 v50, 7, v0
    v_mul_u32_u24 v3, 15360, v49
    v_lshl_add_u32 v3, v50, 4, v3
    s_mul_i32 s7, s98, 384
    s_add_u32 s7, s7, 6592
    v_mul_u32_u24 v39, 48, v49
    v_add_u32 v39, s7, v39
    v_mul_u32_u24 v40, 256, v49
    v_lshl_add_u32 v40, v50, 3, v40
    s_lshr_b32 s7, s96, 7
    s_mul_i32 s8, s12, 10
    s_add_u32 s7, s7, s8
    s_mul_i32 s7, s7, 2048
    s_add_u32 s7, s7, 2691072
    v_add_u32 v40, s7, v40
    v_mov_b32 v53, 0
    v_mov_b32 v54, 1
    s_mov_b32 s62, 117835008
    s_mov_b32 s63, 117835009
    s_mov_b32 s64, 117835010
    s_mov_b32 s65, 117835011
    s_add_u32 s48, s26, s6
    s_addc_u32 s49, s27, 0
    s_sub_u32 s50, 7864320, s6
    s_mov_b32 s51, 0x20000
    s_mov_b32 s52, s30
    s_mov_b32 s53, s31
    s_mov_b32 s54, 2732032
    s_mov_b32 s55, 0x20000
    s_mov_b32 s56, s28
    s_mov_b32 s57, s29
    s_mov_b32 s58, 2560
    s_mov_b32 s59, 0x20000
    s_lshl_b32 s9, s12, 7
    buffer_load_dword v36, v53, s[52:55], s9 offen sc1
    buffer_load_dword v31, v53, s[52:55], s9 offen offset:4 sc1
    v_lshrrev_b32 v49, 4, v0
    v_cmp_eq_u32 vcc, 1, v49
    v_mov_b32 v49, 128
    s_nop 0
    v_cndmask_b32 v49, 0, v49, vcc
    buffer_load_dword v55, v49, s[52:55], 0 offen sc1
    s_cmp_lg_u32 s15, 0
    s_cbranch_scc1 L_ai
    v_mov_b32 v56, 0
    v_mov_b32 v57, 0
    v_mov_b32 v58, 0
    v_mov_b32 v59, 0
    v_mov_b32 v60, 0
    v_mov_b32 v61, 0
    v_mov_b32 v62, 0
    v_mov_b32 v63, 0
    v_mov_b32 v64, 0
    v_mov_b32 v65, 0
    v_mov_b32 v66, 0
    v_mov_b32 v67, 0
    v_mov_b32 v68, 0
    v_mov_b32 v69, 0
    v_mov_b32 v70, 0
    v_mov_b32 v71, 0
    v_mov_b32 v72, 0
    v_mov_b32 v73, 0
    v_mov_b32 v74, 0
    v_mov_b32 v75, 0
    s_mov_b32 s3, 0
    buffer_atomic_swap_x2 v[56:57], v40, s[52:55], s3 offen sc0 sc1
    s_mov_b32 s3, 2048
    buffer_atomic_swap_x2 v[58:59], v40, s[52:55], s3 offen sc0 sc1
    s_mov_b32 s3, 4096
    buffer_atomic_swap_x2 v[60:61], v40, s[52:55], s3 offen sc0 sc1
    s_mov_b32 s3, 6144
    buffer_atomic_swap_x2 v[62:63], v40, s[52:55], s3 offen sc0 sc1
    s_mov_b32 s3, 8192
    buffer_atomic_swap_x2 v[64:65], v40, s[52:55], s3 offen sc0 sc1
    s_mov_b32 s3, 10240
    buffer_atomic_swap_x2 v[66:67], v40, s[52:55], s3 offen sc0 sc1
    s_mov_b32 s3, 12288
    buffer_atomic_swap_x2 v[68:69], v40, s[52:55], s3 offen sc0 sc1
    s_mov_b32 s3, 14336
    buffer_atomic_swap_x2 v[70:71], v40, s[52:55], s3 offen sc0 sc1
    s_mov_b32 s3, 16384
    buffer_atomic_swap_x2 v[72:73], v40, s[52:55], s3 offen sc0 sc1
    s_mov_b32 s3, 18432
    buffer_atomic_swap_x2 v[74:75], v40, s[52:55], s3 offen sc0 sc1
L_ai:
    s_mov_b32 s66, 0x0c0c0400
    s_mov_b32 s67, 0x04000c0c
    s_mov_b32 s18, 0xffffff00
    s_lshl_b32 s7, s11, 2
    s_add_u32 s8, s7, s10
    v_lshlrev_b32 v44, 4, v0
    v_lshrrev_b32 v49, 4, v0
    v_and_b32 v50, 15, v0
    v_mul_u32_u24 v46, 768, v49
    v_lshl_add_u32 v46, v50, 4, v46
    s_mul_i32 s3, s7, 768
    s_add_u32 s3, s3, 4096
    v_add_u32 v46, s3, v46
    v_lshlrev_b32 v48, 10, v49
    s_lshl_b32 s3, s7, 10
    s_add_u32 s3, s3, 200704
    v_add_u32 v48, s3, v48
    v_mov_b32 v51, v50
    v_lshl_add_u32 v47, v51, 4, v48
    v_min_u32 v182, 47, v0
    v_lshlrev_b32 v182, 4, v182
    s_xor_b32 s4, s8, 1
    s_lshl_b32 s4, s4, 10
    s_add_u32 s4, s4, 200704
    v_add_u32 v180, s4, v182
    s_xor_b32 s4, s8, 2
    s_lshl_b32 s4, s4, 10
    s_add_u32 s4, s4, 200704
    v_add_u32 v181, s4, v182
    s_xor_b32 s4, s8, 3
    s_lshl_b32 s4, s4, 10
    s_add_u32 s4, s4, 200704
    v_add_u32 v182, s4, v182
    v_and_b32 v52, 1, v49
    v_lshlrev_b32 v52, 1, v52
    v_lshrrev_b32 v49, 1, v49
    v_or_b32 v52, v52, v49
    v_lshl_add_u32 v41, v50, 2, v52
    v_lshlrev_b32 v41, 1, v41
    v_add_u32 v41, 6144, v41
    v_lshl_add_u32 v42, v51, 2, v52
    v_lshlrev_b32 v42, 2, v42
    v_add_u32 v42, 6592, v42
    v_and_b32 v49, 7, v0
    v_lshlrev_b32 v43, 4, v49
    v_bfe_u32 v49, v0, 4, 1
    v_lshl_add_u32 v43, v49, 3, v43
    v_lshrrev_b32 v49, 5, v0
    v_lshl_add_u32 v43, v49, 2, v43
    v_bfe_u32 v49, v0, 3, 1
    v_lshl_add_u32 v43, v49, 1, v43
    s_mul_i32 s3, s12, 1280
    s_add_u32 s3, s3, s96
    v_add_u32 v43, s3, v43
    s_mul_i32 s4, s8, 768
    s_add_u32 s4, s4, 4096
    s_lshl_b32 s5, s8, 10
    s_add_u32 s5, s5, 200704
    s_mov_b32 s4, s5
    s_add_u32 s6, s4, 2228224
    s_add_u32 s7, s5, 2228224
    s_barrier
    s_waitcnt vmcnt(0)
    v_and_b32 v49, 0x7f7f7f7f, v36
    v_add_u32 v49, 0x01010101, v49
    v_and_b32 v36, 0x80808080, v36
    v_xor_b32 v36, v36, v49
    ds_write_b32 v53, v36 offset:6528
    s_cmp_lg_u32 s15, 0
    s_cbranch_scc1 L_aj
    s_mov_b64 exec, 1
    buffer_store_dword v36, v53, s[52:55], s9 offen offset:256 sc1
    s_mov_b64 exec, -1
L_aj:
    v_and_b32 v49, 0x7f7f7f7f, v55
    v_add_u32 v49, 0x01010101, v49
    v_and_b32 v55, 0x80808080, v55
    v_xor_b32 v55, v55, v49
    v_and_b32 v55, s18, v55
    s_mov_b32 s19, 4000000
L_f1:
    ds_read_b32 v49, v53 offset:6544
    s_sub_u32 s19, s19, 1
    s_waitcnt lgkmcnt(0)
    v_readfirstlane_b32 s3, v49
    s_cmp_eq_u32 s19, 0
    s_cbranch_scc1 L_f1_x
    s_cmp_lt_u32 s3, 4
    s_cbranch_scc1 L_f1
L_f1_x:
    ds_read_b128 v[56:59], v44 offset:0
    ds_read_b128 v[60:63], v44 offset:768
    ds_read_b128 v[64:67], v44 offset:1536
    ds_read_b128 v[68:71], v44 offset:2304
    ds_read_b128 v[72:75], v44 offset:3072
    ds_read_b128 v[76:79], v44 offset:3840
    ds_read_b128 v[80:83], v44 offset:4608
    ds_read_b128 v[84:87], v44 offset:5376
    s_waitcnt lgkmcnt(6)
    v_add_f32 v56, v56, v60
    v_add_f32 v57, v57, v61
    v_add_f32 v58, v58, v62
    v_add_f32 v59, v59, v63
    s_waitcnt lgkmcnt(5)
    v_add_f32 v56, v56, v64
    v_add_f32 v57, v57, v65
    v_add_f32 v58, v58, v66
    v_add_f32 v59, v59, v67
    s_waitcnt lgkmcnt(4)
    v_add_f32 v56, v56, v68
    v_add_f32 v57, v57, v69
    v_add_f32 v58, v58, v70
    v_add_f32 v59, v59, v71
    s_waitcnt lgkmcnt(3)
    v_add_f32 v56, v56, v72
    v_add_f32 v57, v57, v73
    v_add_f32 v58, v58, v74
    v_add_f32 v59, v59, v75
    s_waitcnt lgkmcnt(2)
    v_add_f32 v56, v56, v76
    v_add_f32 v57, v57, v77
    v_add_f32 v58, v58, v78
    v_add_f32 v59, v59, v79
    s_waitcnt lgkmcnt(1)
    v_add_f32 v56, v56, v80
    v_add_f32 v57, v57, v81
    v_add_f32 v58, v58, v82
    v_add_f32 v59, v59, v83
    s_waitcnt lgkmcnt(0)
    v_add_f32 v56, v56, v84
    v_add_f32 v57, v57, v85
    v_add_f32 v58, v58, v86
    v_add_f32 v59, v59, v87
    v_perm_b32 v124, v56, v36, s62
    v_perm_b32 v125, v57, v36, s63
    v_perm_b32 v126, v58, v36, s64
    v_perm_b32 v127, v59, v36, s65
    s_mov_b32 exec_hi, 0xffff
    buffer_store_dwordx4 v[124:127], v44, s[52:55], s4 offen
    s_mov_b64 exec, -1
    s_mov_b32 s19, 4000000
L_qd:
    ds_read_b32 v49, v53 offset:6556
    s_sub_u32 s19, s19, 1
    s_cbranch_scc1 L_qdx
    s_waitcnt lgkmcnt(0)
    v_readfirstlane_b32 s3, v49
    s_cmp_lt_u32 s3, 20
    s_cbranch_scc1 L_qd
L_qdx:
    s_mov_b32 s19, 400000
    s_mov_b32 s101, 0
L_p1:
    s_nop 1
    buffer_load_dwordx4 v[56:59], v47, s[52:55], s101 offen offset:0 sc1
    buffer_load_dwordx4 v[60:63], v47, s[52:55], s101 offen offset:256 sc1
    buffer_load_dwordx4 v[64:67], v47, s[52:55], s101 offen offset:512 sc1
    s_sub_u32 s19, s19, 1
    s_cmp_lg_u32 s19, 399968
    s_cbranch_scc1 L_p1_y
    s_mov_b32 exec_hi, 0xffff
    buffer_store_dwordx4 v[124:127], v44, s[52:55], s6 offen sc1
    s_mov_b64 exec, -1
L_p1_y:
    s_cmp_lt_u32 s19, 399968
    s_cselect_b32 s3, 2228224, 0
    s_xor_b32 s101, s101, s3
    s_waitcnt vmcnt(0)
    v_perm_b32 v49, v57, v56, s66
    v_perm_b32 v50, v59, v58, s67
    v_or_b32 v49, v49, v50
    v_xor_b32 v51, v49, v36
    v_perm_b32 v49, v61, v60, s66
    v_perm_b32 v50, v63, v62, s67
    v_or_b32 v49, v49, v50
    v_xor_b32 v49, v49, v36
    v_or_b32 v51, v51, v49
    v_perm_b32 v49, v65, v64, s66
    v_perm_b32 v50, v67, v66, s67
    v_or_b32 v49, v49, v50
    v_xor_b32 v49, v49, v36
    v_or_b32 v51, v51, v49
    v_cmp_ne_u32 vcc, 0, v51
    s_cmp_eq_u32 s19, 0
    s_cbranch_scc1 L_p1_x
    s_cbranch_vccnz L_p1
L_p1_x:
    v_and_b32 v56, s18, v56
    v_and_b32 v57, s18, v57
    v_and_b32 v58, s18, v58
    v_and_b32 v59, s18, v59
    v_and_b32 v60, s18, v60
    v_and_b32 v61, s18, v61
    v_and_b32 v62, s18, v62
    v_and_b32 v63, s18, v63
    v_and_b32 v64, s18, v64
    v_and_b32 v65, s18, v65
    v_and_b32 v66, s18, v66
    v_and_b32 v67, s18, v67
    v_permlane32_swap_b32 v56, v57
    v_permlane32_swap_b32 v58, v59
    v_add_f32 v56, v56, v57
    v_add_f32 v58, v58, v59
    s_nop 1
    v_permlane16_swap_b32 v56, v58
    v_add_f32 v56, v56, v58
    v_permlane32_swap_b32 v60, v61
    v_permlane32_swap_b32 v62, v63
    v_add_f32 v60, v60, v61
    v_add_f32 v62, v62, v63
    s_nop 1
    v_permlane16_swap_b32 v60, v62
    v_add_f32 v60, v60, v62
    v_permlane32_swap_b32 v64, v65
    v_permlane32_swap_b32 v66, v67
    v_add_f32 v64, v64, v65
    v_add_f32 v66, v66, v67
    s_nop 1
    v_permlane16_swap_b32 v64, v66
    v_add_f32 v64, v64, v66
    v_cvt_pk_bf16_f32 v56, v56, v56
    v_cvt_pk_bf16_f32 v60, v60, v60
    v_cvt_pk_bf16_f32 v64, v64, v64
    ds_write_b16 v41, v56 offset:0
    ds_write_b16 v41, v60 offset:128
    ds_write_b16 v41, v64 offset:256
    ds_write_b32 v53, v54 offset:6532
    global_load_dwordx4 v[72:75], v44, s[22:23]
    global_load_dwordx4 v[76:79], v44, s[26:27]
    s_waitcnt vmcnt(0)
    v_and_b32 v72, 0x7fff7fff, v72
    v_and_b32 v73, 0x7fff7fff, v73
    v_and_b32 v74, 0x7fff7fff, v74
    v_and_b32 v75, 0x7fff7fff, v75
    v_and_b32 v76, 0x7fff7fff, v76
    v_and_b32 v77, 0x7fff7fff, v77
    v_and_b32 v78, 0x7fff7fff, v78
    v_and_b32 v79, 0x7fff7fff, v79
    v_pk_max_u16 v72, v72, v73
    v_pk_max_u16 v74, v74, v75
    v_pk_max_u16 v72, v72, v74
    v_lshrrev_b32 v73, 16, v72
    v_and_b32 v72, 0xffff, v72
    v_max_u32 v72, v72, v73
    s_nop 1
    v_max_u32_dpp v72, v72, v72 quad_perm:[1,0,3,2] row_mask:0xf bank_mask:0xf
    s_nop 1
    v_max_u32_dpp v72, v72, v72 quad_perm:[2,3,0,1] row_mask:0xf bank_mask:0xf
    s_nop 1
    v_max_u32_dpp v72, v72, v72 row_half_mirror row_mask:0xf bank_mask:0xf
    s_nop 1
    v_max_u32_dpp v72, v72, v72 row_mirror row_mask:0xf bank_mask:0xf
    v_mov_b32 v73, v72
    s_nop 1
    v_permlane16_swap_b32 v72, v73
    v_max_u32 v72, v72, v73
    v_mov_b32 v73, v72
    s_nop 1
    v_permlane32_swap_b32 v72, v73
    v_max_u32 v72, v72, v73
    v_lshrrev_b32 v72, 7, v72
    v_pk_max_u16 v76, v76, v77
    v_pk_max_u16 v78, v78, v79
    v_pk_max_u16 v76, v76, v78
    v_lshrrev_b32 v77, 16, v76
    v_and_b32 v76, 0xffff, v76
    v_max_u32 v76, v76, v77
    s_nop 1
    v_max_u32_dpp v76, v76, v76 quad_perm:[1,0,3,2] row_mask:0xf bank_mask:0xf
    s_nop 1
    v_max_u32_dpp v76, v76, v76 quad_perm:[2,3,0,1] row_mask:0xf bank_mask:0xf
    s_nop 1
    v_max_u32_dpp v76, v76, v76 row_half_mirror row_mask:0xf bank_mask:0xf
    s_nop 1
    v_max_u32_dpp v76, v76, v76 row_mirror row_mask:0xf bank_mask:0xf
    v_mov_b32 v77, v76
    s_nop 1
    v_permlane16_swap_b32 v76, v77
    v_max_u32 v76, v76, v77
    v_mov_b32 v77, v76
    s_nop 1
    v_permlane32_swap_b32 v76, v77
    v_max_u32 v76, v76, v77
    v_lshrrev_b32 v76, 7, v76
    v_add_u32 v49, v72, v76
    v_sub_u32 v49, 285, v49
    v_min_i32 v49, 120, v49
    v_max_i32 v49, -100, v49
    v_mov_b32 v28, 0
    v_add_u32 v29, 1023, v49
    v_lshlrev_b32 v29, 20, v29
    v_sub_u32 v30, 127, v49
    v_lshlrev_b32 v30, 23, v30
    s_mov_b32 s3, 0x9e3779b1
    v_mul_lo_u32 v31, v31, s3
    v_add_u32 v31, 1, v31
    ds_write_b128 v53, v[28:31] offset:7888
    s_mov_b32 s19, 400000
L_ak:
    buffer_load_dword v49, v53, s[52:55], s9 offen offset:256 sc1
    s_sub_u32 s19, s19, 1
    s_cbranch_scc1 L_akx
    s_waitcnt vmcnt(0)
    v_cmp_ne_u32 vcc, v49, v36
    s_cbranch_vccnz L_ak
L_akx:
    s_waitcnt vmcnt(0)
    s_and_b32 s3, s2, 7
    s_mul_i32 s3, s3, 4352
    s_add_u32 s3, s3, 1118208
    s_lshr_b32 s37, s2, 3
    v_and_b32 v49, 31, v0
    v_lshl_add_u32 v45, v49, 2, s3
    s_lshl_b32 s33, s37, 2
    s_add_u32 s33, s33, s3
    s_getreg_b32 s3, hwreg(HW_REG_XCC_ID, 0, 1)
    s_cmp_eq_u32 s3, 1
    s_cselect_b32 s43, -2, 2
    s_mov_b32 s32, 0
    s_and_b32 s3, s37, 7
    s_add_u32 s35, s3, 48
    s_mov_b32 s34, 0
    s_mov_b64 s[38:39], 0
    s_mov_b32 s19, 4000000
L_f2:
    ds_read_b128 v[56:59], v53 offset:6544
    s_sub_u32 s19, s19, 1
    s_cbranch_scc1 L_f2_x
    s_waitcnt lgkmcnt(0)
    v_readfirstlane_b32 s3, v57
    v_readfirstlane_b32 s36, v59
    s_cmp_ge_u32 s3, 4
    s_cbranch_scc1 L_f2_x
    s_sub_i32 s36, s36, s34
    s_cmp_lt_i32 s36, s35
    s_cbranch_scc1 L_f2
    s_sub_i32 s37, s36, s35
    s_lshr_b32 s37, s37, 3
    s_add_u32 s37, s37, 1
    s_add_u32 s32, s32, s37
    v_and_b32 v56, s18, v36
    v_or_b32 v57, s32, v56
    buffer_load_dword v58, v45, s[52:55], 0 offen sc1
    s_mov_b64 exec, 1
    buffer_store_dword v57, v53, s[52:55], s33 offen
    s_mov_b64 exec, -1
    s_lshl_b32 s37, s37, 3
    s_add_u32 s35, s35, s37
    s_cmp_gt_i32 s35, 239
    s_cselect_b32 s35, 0x7fffffff, s35
    s_waitcnt vmcnt(1)
    v_xor_b32 v58, v58, v55
    v_cmp_gt_u32 vcc, 64, v58
    s_nop 1
    v_cndmask_b32 v58, 0, v58, vcc
    s_nop 1
    v_add_u32_dpp v58, v58, v58 quad_perm:[1,0,3,2] row_mask:0xf bank_mask:0xf
    s_nop 1
    v_add_u32_dpp v58, v58, v58 quad_perm:[2,3,0,1] row_mask:0xf bank_mask:0xf
    s_nop 1
    v_add_u32_dpp v58, v58, v58 row_half_mirror row_mask:0xf bank_mask:0xf
    s_nop 1
    v_add_u32_dpp v58, v58, v58 row_mirror row_mask:0xf bank_mask:0xf
    s_nop 0
    v_readlane_b32 s37, v58, 0
    v_readlane_b32 s3, v58, 16
    s_add_u32 s37, s37, s3
    s_add_i32 s37, s37, s43
    s_lshl_b32 s3, s36, 2
    s_sub_i32 s3, s37, s3
    s_add_u32 s3, s3, 202
    s_ashr_i32 s3, s3, 3
    s_min_i32 s3, s3, 4
    s_max_i32 s3, s3, -4
    s_sub_i32 s37, s3, s34
    s_mov_b32 s34, s3
    v_mov_b32 v56, s37
    s_mov_b64 exec, 1
    ds_add_u32 v53, v56 offset:6556
    s_mov_b64 exec, -1
    s_branch L_f2
L_f2_x:
    ds_read_b128 v[12:15], v53 offset:6560
    ds_read_b128 v[16:19], v53 offset:6576
    s_waitcnt lgkmcnt(0)
    v_max_f32 v49, v12, v14
    v_max3_f32 v49, v49, v16, v18
    v_sub_f32 v8, v12, v49
    v_sub_f32 v9, v14, v49
    v_sub_f32 v10, v16, v49
    v_sub_f32 v11, v18, v49
    v_exp_f32 v8, v8
    v_exp_f32 v9, v9
    v_exp_f32 v10, v10
    v_exp_f32 v11, v11
    v_mul_f32 v58, v8, v13
    v_fma_f32 v58, v9, v15, v58
    v_fma_f32 v58, v10, v17, v58
    v_fma_f32 v58, v11, v19, v58
    v_and_b32 v56, s18, v49
    v_sub_f32 v57, v49, v56
    s_getreg_b32 s99, hwreg(HW_REG_XCC_ID, 0, 16)
    s_lshl_b32 s99, s99, 8
    v_mov_b32 v59, s99
    v_perm_b32 v128, v56, v36, s62
    v_perm_b32 v129, v57, v36, s63
    v_perm_b32 v130, v58, v36, s64
    v_perm_b32 v131, v59, v36, s65
    s_mov_b64 exec, 1
    buffer_store_dwordx4 v[128:131], v53, s[52:55], s5 offen offset:768
    s_mov_b64 exec, -1
    s_mov_b32 s19, 400000
    s_mov_b32 s101, 0
L_p2:
    s_nop 1
    buffer_load_dwordx4 v[56:59], v48, s[52:55], s101 offen offset:768 sc1
    s_sub_u32 s19, s19, 1
    s_cmp_lg_u32 s19, 399968
    s_cbranch_scc1 L_p2_y
    s_mov_b32 exec_hi, 0xffff
    buffer_store_dwordx4 v[124:127], v44, s[52:55], s6 offen sc1
    s_mov_b64 exec, -1
    s_mov_b64 exec, 1
    buffer_store_dwordx4 v[128:131], v53, s[52:55], s7 offen offset:768 sc1
    s_mov_b64 exec, -1
L_p2_y:
    s_cmp_lt_u32 s19, 399968
    s_cselect_b32 s3, 2228224, 0
    s_xor_b32 s101, s101, s3
    s_waitcnt vmcnt(0)
    v_perm_b32 v49, v57, v56, s66
    v_perm_b32 v50, v59, v58, s67
    v_or_b32 v49, v49, v50
    v_xor_b32 v51, v49, v36
    v_cmp_ne_u32 vcc, 0, v51
    s_cmp_eq_u32 s19, 0
    s_cbranch_scc1 L_p2_x
    s_cbranch_vccnz L_p2
L_p2_x:
    v_and_b32 v56, s18, v56
    v_and_b32 v57, s18, v57
    v_and_b32 v58, s18, v58
    v_and_b32 v59, s18, v59
    v_cmp_ne_u32 vcc, s99, v59
    s_or_b32 s99, vcc_lo, vcc_hi
    v_add_f32 v56, v56, v57
    v_mov_b32 v57, v56
    v_mov_b32 v49, v57
    s_nop 1
    v_permlane16_swap_b32 v57, v49
    v_max_f32 v57, v57, v49
    v_mov_b32 v49, v57
    s_nop 1
    v_permlane32_swap_b32 v57, v49
    v_max_f32 v57, v57, v49
    v_sub_f32 v56, v56, v57
    v_exp_f32 v56, v56
    s_nop 0
    v_mul_f32 v56, v56, v58
    v_mov_b32 v49, v56
    s_nop 1
    v_permlane16_swap_b32 v56, v49
    v_add_f32 v56, v56, v49
    v_mov_b32 v49, v56
    s_nop 1
    v_permlane32_swap_b32 v56, v49
    v_add_f32 v56, v56, v49
    v_rcp_f32 v56, v56
    v_sub_f32 v8, v12, v57
    v_sub_f32 v9, v14, v57
    v_sub_f32 v10, v16, v57
    v_sub_f32 v11, v18, v57
    v_exp_f32 v8, v8
    v_exp_f32 v9, v9
    v_exp_f32 v10, v10
    v_exp_f32 v11, v11
    v_mul_f32 v8, v8, v56
    v_mul_f32 v9, v9, v56
    v_mul_f32 v10, v10, v56
    v_mul_f32 v11, v11, v56
    s_mov_b32 s19, 4000000
L_f3:
    ds_read_b128 v[60:63], v53 offset:6544
    s_sub_u32 s19, s19, 1
    s_cbranch_scc1 L_f3_x
    s_waitcnt lgkmcnt(0)
    v_readfirstlane_b32 s3, v62
    v_readfirstlane_b32 s36, v63
    s_cmp_ge_u32 s3, 4
    s_cbranch_scc1 L_f3_x
    s_sub_i32 s36, s36, s34
    s_cmp_lt_i32 s36, s35
    s_cbranch_scc1 L_f3
    s_sub_i32 s37, s36, s35
    s_lshr_b32 s37, s37, 3
    s_add_u32 s37, s37, 1
    s_add_u32 s32, s32, s37
    v_and_b32 v60, s18, v36
    v_or_b32 v61, s32, v60
    buffer_load_dword v62, v45, s[52:55], 0 offen sc1
    s_mov_b64 exec, 1
    buffer_store_dword v61, v53, s[52:55], s33 offen
    s_mov_b64 exec, -1
    s_lshl_b32 s37, s37, 3
    s_add_u32 s35, s35, s37
    s_cmp_gt_i32 s35, 239
    s_cselect_b32 s35, 0x7fffffff, s35
    s_waitcnt vmcnt(1)
    v_xor_b32 v62, v62, v55
    v_cmp_gt_u32 vcc, 64, v62
    s_nop 1
    v_cndmask_b32 v62, 0, v62, vcc
    s_nop 1
    v_add_u32_dpp v62, v62, v62 quad_perm:[1,0,3,2] row_mask:0xf bank_mask:0xf
    s_nop 1
    v_add_u32_dpp v62, v62, v62 quad_perm:[2,3,0,1] row_mask:0xf bank_mask:0xf
    s_nop 1
    v_add_u32_dpp v62, v62, v62 row_half_mirror row_mask:0xf bank_mask:0xf
    s_nop 1
    v_add_u32_dpp v62, v62, v62 row_mirror row_mask:0xf bank_mask:0xf
    s_nop 0
    v_readlane_b32 s37, v62, 0
    v_readlane_b32 s3, v62, 16
    s_add_u32 s37, s37, s3
    s_add_i32 s37, s37, s43
    s_lshl_b32 s3, s36, 2
    s_sub_i32 s3, s37, s3
    s_add_u32 s3, s3, 202
    s_ashr_i32 s3, s3, 3
    s_min_i32 s3, s3, 4
    s_max_i32 s3, s3, -4
    s_sub_i32 s37, s3, s34
    s_mov_b32 s34, s3
    v_mov_b32 v60, s37
    s_mov_b64 exec, 1
    ds_add_u32 v53, v60 offset:6556
    s_mov_b64 exec, -1
    s_branch L_f3
L_f3_x:
    ds_read_b128 v[56:59], v44 offset:0
    ds_read_b128 v[60:63], v44 offset:768
    ds_read_b128 v[64:67], v44 offset:1536
    ds_read_b128 v[68:71], v44 offset:2304
    ds_read_b128 v[72:75], v44 offset:3072
    ds_read_b128 v[76:79], v44 offset:3840
    ds_read_b128 v[80:83], v44 offset:4608
    ds_read_b128 v[84:87], v44 offset:5376
    v_xor_b32 v36, 0x80808080, v36
    s_waitcnt lgkmcnt(6)
    v_pk_add_f32 v[56:57], v[56:57], v[60:61]
    v_pk_add_f32 v[58:59], v[58:59], v[62:63]
    v_pk_mul_f32 v[56:57], v[8:9], v[56:57] op_sel_hi:[0,1]
    v_pk_mul_f32 v[58:59], v[8:9], v[58:59] op_sel_hi:[0,1]
    s_waitcnt lgkmcnt(4)
    v_pk_add_f32 v[64:65], v[64:65], v[68:69]
    v_pk_add_f32 v[66:67], v[66:67], v[70:71]
    v_pk_fma_f32 v[56:57], v[8:9], v[64:65], v[56:57] op_sel:[1,0,0] op_sel_hi:[1,1,1]
    v_pk_fma_f32 v[58:59], v[8:9], v[66:67], v[58:59] op_sel:[1,0,0] op_sel_hi:[1,1,1]
    s_waitcnt lgkmcnt(2)
    v_pk_add_f32 v[72:73], v[72:73], v[76:77]
    v_pk_add_f32 v[74:75], v[74:75], v[78:79]
    v_pk_fma_f32 v[56:57], v[10:11], v[72:73], v[56:57] op_sel_hi:[0,1,1]
    v_pk_fma_f32 v[58:59], v[10:11], v[74:75], v[58:59] op_sel_hi:[0,1,1]
    s_waitcnt lgkmcnt(0)
    v_pk_add_f32 v[80:81], v[80:81], v[84:85]
    v_pk_add_f32 v[82:83], v[82:83], v[86:87]
    v_pk_fma_f32 v[56:57], v[10:11], v[80:81], v[56:57] op_sel:[1,0,0] op_sel_hi:[1,1,1]
    v_pk_fma_f32 v[58:59], v[10:11], v[82:83], v[58:59] op_sel:[1,0,0] op_sel_hi:[1,1,1]
    v_perm_b32 v24, v56, v36, s62
    v_perm_b32 v25, v57, v36, s63
    v_perm_b32 v26, v58, v36, s64
    v_perm_b32 v27, v59, v36, s65
    s_mov_b32 exec_hi, 0xffff
    buffer_store_dwordx4 v[24:27], v44, s[52:55], s5 offen
    s_mov_b64 exec, -1
    s_cmp_eq_u32 s99, 0
    s_cbranch_scc1 L_same
    s_mov_b64 exec, 1
    buffer_store_dwordx4 v[128:131], v53, s[52:55], s7 offen offset:768 sc1
    s_mov_b64 exec, -1
    s_mov_b32 exec_hi, 0xffff
    buffer_store_dwordx4 v[24:27], v44, s[52:55], s7 offen sc1
    s_mov_b64 exec, -1
L_same:
    buffer_load_dwordx4 v[140:143], v180, s[52:55], 0 offen sc1
    buffer_load_dwordx4 v[144:147], v181, s[52:55], 0 offen sc1
    buffer_load_dwordx4 v[148:151], v182, s[52:55], 0 offen sc1
    ds_write_b32 v53, v54 offset:7876
    s_mov_b32 s19, 4000000
L_k1:
    ds_read_b32 v49, v53 offset:7880
    s_sub_u32 s19, s19, 1
    s_cbranch_scc1 L_k1x
    s_waitcnt lgkmcnt(0)
    v_readfirstlane_b32 s3, v49
    s_cmp_lt_u32 s3, 6
    s_cbranch_scc1 L_k1
L_k1x:
    buffer_load_dwordx4 v[152:155], v180, s[52:55], 0 offen sc1
    buffer_load_dwordx4 v[156:159], v181, s[52:55], 0 offen sc1
    buffer_load_dwordx4 v[160:163], v182, s[52:55], 0 offen sc1
    s_mov_b32 s19, 4000000
L_k2:
    ds_read_b32 v49, v53 offset:7880
    s_sub_u32 s19, s19, 1
    s_cbranch_scc1 L_k2x
    s_waitcnt lgkmcnt(0)
    v_readfirstlane_b32 s3, v49
    s_cmp_lt_u32 s3, 12
    s_cbranch_scc1 L_k2
L_k2x:
    buffer_load_dwordx4 v[164:167], v180, s[52:55], 0 offen sc1
    buffer_load_dwordx4 v[168:171], v181, s[52:55], 0 offen sc1
    buffer_load_dwordx4 v[172:175], v182, s[52:55], 0 offen sc1
    s_mov_b32 s19, 32
L_pq:
    s_waitcnt vmcnt(6)
    v_perm_b32 v49, v141, v140, s66
    v_perm_b32 v52, v143, v142, s67
    v_bitop3_b32 v49, v49, v52, v36 bitop3:0x56
    v_perm_b32 v50, v145, v144, s66
    v_perm_b32 v52, v147, v146, s67
    v_bitop3_b32 v50, v50, v52, v36 bitop3:0x56
    v_perm_b32 v51, v149, v148, s66
    v_perm_b32 v52, v151, v150, s67
    v_bitop3_b32 v51, v51, v52, v36 bitop3:0x56
    v_or3_b32 v51, v49, v50, v51
    v_cmp_ne_u32 vcc, 0, v51
    v_and_b32 v60, s18, v140
    v_and_b32 v61, s18, v141
    v_and_b32 v62, s18, v142
    v_and_b32 v63, s18, v143
    v_and_b32 v64, s18, v144
    v_and_b32 v65, s18, v145
    v_and_b32 v66, s18, v146
    v_and_b32 v67, s18, v147
    v_and_b32 v68, s18, v148
    v_and_b32 v69, s18, v149
    v_and_b32 v70, s18, v150
    v_and_b32 v71, s18, v151
    s_and_b64 exec, exec, vcc
    s_cbranch_scc0 L_pqx
    buffer_load_dwordx4 v[140:143], v180, s[52:55], 0 offen sc1
    buffer_load_dwordx4 v[144:147], v181, s[52:55], 0 offen sc1
    buffer_load_dwordx4 v[148:151], v182, s[52:55], 0 offen sc1
    s_waitcnt vmcnt(6)
    v_perm_b32 v49, v153, v152, s66
    v_perm_b32 v52, v155, v154, s67
    v_bitop3_b32 v49, v49, v52, v36 bitop3:0x56
    v_perm_b32 v50, v157, v156, s66
    v_perm_b32 v52, v159, v158, s67
    v_bitop3_b32 v50, v50, v52, v36 bitop3:0x56
    v_perm_b32 v51, v161, v160, s66
    v_perm_b32 v52, v163, v162, s67
    v_bitop3_b32 v51, v51, v52, v36 bitop3:0x56
    v_or3_b32 v51, v49, v50, v51
    v_cmp_ne_u32 vcc, 0, v51
    v_and_b32 v60, s18, v152
    v_and_b32 v61, s18, v153
    v_and_b32 v62, s18, v154
    v_and_b32 v63, s18, v155
    v_and_b32 v64, s18, v156
    v_and_b32 v65, s18, v157
    v_and_b32 v66, s18, v158
    v_and_b32 v67, s18, v159
    v_and_b32 v68, s18, v160
    v_and_b32 v69, s18, v161
    v_and_b32 v70, s18, v162
    v_and_b32 v71, s18, v163
    s_and_b64 exec, exec, vcc
    s_cbranch_scc0 L_pqx
    buffer_load_dwordx4 v[152:155], v180, s[52:55], 0 offen sc1
    buffer_load_dwordx4 v[156:159], v181, s[52:55], 0 offen sc1
    buffer_load_dwordx4 v[160:163], v182, s[52:55], 0 offen sc1
    s_waitcnt vmcnt(6)
    v_perm_b32 v49, v165, v164, s66
    v_perm_b32 v52, v167, v166, s67
    v_bitop3_b32 v49, v49, v52, v36 bitop3:0x56
    v_perm_b32 v50, v169, v168, s66
    v_perm_b32 v52, v171, v170, s67
    v_bitop3_b32 v50, v50, v52, v36 bitop3:0x56
    v_perm_b32 v51, v173, v172, s66
    v_perm_b32 v52, v175, v174, s67
    v_bitop3_b32 v51, v51, v52, v36 bitop3:0x56
    v_or3_b32 v51, v49, v50, v51
    v_cmp_ne_u32 vcc, 0, v51
    v_and_b32 v60, s18, v164
    v_and_b32 v61, s18, v165
    v_and_b32 v62, s18, v166
    v_and_b32 v63, s18, v167
    v_and_b32 v64, s18, v168
    v_and_b32 v65, s18, v169
    v_and_b32 v66, s18, v170
    v_and_b32 v67, s18, v171
    v_and_b32 v68, s18, v172
    v_and_b32 v69, s18, v173
    v_and_b32 v70, s18, v174
    v_and_b32 v71, s18, v175
    s_and_b64 exec, exec, vcc
    s_cbranch_scc0 L_pqx
    buffer_load_dwordx4 v[164:167], v180, s[52:55], 0 offen sc1
    buffer_load_dwordx4 v[168:171], v181, s[52:55], 0 offen sc1
    buffer_load_dwordx4 v[172:175], v182, s[52:55], 0 offen sc1
    s_sub_u32 s19, s19, 1
    s_cbranch_scc0 L_pq
    s_mov_b64 exec, -1
    s_mov_b32 s19, 400000
    s_mov_b32 s101, 0
L_p3:
    s_nop 1
    buffer_load_dwordx4 v[60:63], v180, s[52:55], s101 offen sc1
    buffer_load_dwordx4 v[64:67], v181, s[52:55], s101 offen sc1
    buffer_load_dwordx4 v[68:71], v182, s[52:55], s101 offen sc1
    ds_write_b32 v53, v54 offset:7876
    s_sub_u32 s19, s19, 1
    s_cmp_lg_u32 s19, 399968
    s_cbranch_scc1 L_p3_y
    s_mov_b64 exec, 1
    buffer_store_dwordx4 v[128:131], v53, s[52:55], s7 offen offset:768 sc1
    s_mov_b64 exec, -1
    s_mov_b32 exec_hi, 0xffff
    buffer_store_dwordx4 v[24:27], v44, s[52:55], s7 offen sc1
    s_mov_b64 exec, -1
L_p3_y:
    s_cmp_lt_u32 s19, 399968
    s_cselect_b32 s3, 2228224, 0
    s_xor_b32 s101, s101, s3
    s_waitcnt vmcnt(0)
    v_perm_b32 v49, v61, v60, s66
    v_perm_b32 v50, v63, v62, s67
    v_or_b32 v49, v49, v50
    v_xor_b32 v51, v49, v36
    v_perm_b32 v49, v65, v64, s66
    v_perm_b32 v50, v67, v66, s67
    v_or_b32 v49, v49, v50
    v_xor_b32 v49, v49, v36
    v_or_b32 v51, v51, v49
    v_perm_b32 v49, v69, v68, s66
    v_perm_b32 v50, v71, v70, s67
    v_or_b32 v49, v49, v50
    v_xor_b32 v49, v49, v36
    v_or_b32 v51, v51, v49
    v_cmp_ne_u32 vcc, 0, v51
    s_cmp_eq_u32 s19, 0
    s_cbranch_scc1 L_p3_x
    s_cbranch_vccnz L_p3
L_p3_x:
    v_and_b32 v60, s18, v60
    v_and_b32 v61, s18, v61
    v_and_b32 v62, s18, v62
    v_and_b32 v63, s18, v63
    v_and_b32 v64, s18, v64
    v_and_b32 v65, s18, v65
    v_and_b32 v66, s18, v66
    v_and_b32 v67, s18, v67
    v_and_b32 v68, s18, v68
    v_and_b32 v69, s18, v69
    v_and_b32 v70, s18, v70
    v_and_b32 v71, s18, v71
L_pqx:
    s_bfm_b64 exec, 48, 0
    v_pk_add_f32 v[56:57], v[56:57], v[60:61]
    v_pk_add_f32 v[58:59], v[58:59], v[62:63]
    v_pk_add_f32 v[64:65], v[64:65], v[68:69]
    v_pk_add_f32 v[66:67], v[66:67], v[70:71]
    v_pk_add_f32 v[56:57], v[56:57], v[64:65]
    v_pk_add_f32 v[58:59], v[58:59], v[66:67]
    v_cvt_pk_bf16_f32 v56, v56, v56
    v_cvt_pk_bf16_f32 v57, v57, v57
    v_cvt_pk_bf16_f32 v58, v58, v58
    v_cvt_pk_bf16_f32 v59, v59, v59
    ds_write_b128 v44, v[56:59] offset:6592
    s_mov_b64 exec, -1
    s_waitcnt lgkmcnt(0)
    s_barrier
    s_waitcnt vmcnt(0)
L_reduce:
    s_nop 4
L_sdone:
    s_mov_b64 exec, -1
L_end:
    s_endpgm
.section .rodata,"a"
.p2align 6
.amdhsa_kernel concat_heads__mha_block_cached__gqa_block_cached__decode_kernel
  .amdhsa_next_free_vgpr 256
  .amdhsa_next_free_sgpr 102
  .amdhsa_accum_offset 256
  .amdhsa_group_segment_fixed_size 0
  .amdhsa_kernarg_size 104
  .amdhsa_user_sgpr_count 2
  .amdhsa_user_sgpr_kernarg_segment_ptr 1
  .amdhsa_system_sgpr_workgroup_id_x 1
.end_amdhsa_kernel
```
